```python
import torch

def _softmax(x, axis=-1):
    return torch.softmax(x, dim=axis)
def _gelu(x):
    return torch.nn.functional.gelu(x, approximate="tanh")
def _silu(x):
    return torch.nn.functional.silu(x)
def _sigmoid(x):
    return torch.sigmoid(x)
def _layernorm(x, axis=-1, eps=1e-5):
    m = x.mean(dim=axis, keepdim=True)
    v = x.var(dim=axis, keepdim=True, unbiased=False)
    return (x - m) / torch.sqrt(v + eps)
def _scatter_add(tgt, idx, src, axis=0):
    return tgt.clone().index_add_(axis, idx, src)
def _segment_sum(src, seg, n):
    out = torch.zeros((n,) + src.shape[1:], dtype=src.dtype)
    return out.index_add_(0, seg, src)
def _pad(x, pw):
    flat = tuple(v for pair in reversed(pw) for v in pair)
    return torch.nn.functional.pad(x, flat)

kernel_name = 'interleave_layers__sliding_block_cached__glu_gated_bilinear__decode'

def setup_inputs():

    _w = (lambda a: (lambda t: t.to(torch.bfloat16) if t.is_floating_point() else t)(torch.as_tensor(a)))
    def _A_setup():
        B, Sq, D = 1, 1, 576
        Hq, Hkv, Sk, Dh = 32, 16, 32768, 128
        assert Hq % Hkv == 0, (Hq, Hkv)
        return {
            "x": _w((lambda *s: torch.randn(*s, dtype=torch.bfloat16) * 0.05)(B, Sq, D)),
            "k_cache": _w((lambda *s: torch.randn(*s, dtype=torch.bfloat16) * 0.8)(B, Hkv, Sk, Dh)),
            "v_cache": _w((lambda *s: torch.randn(*s, dtype=torch.bfloat16) * 0.8)(B, Hkv, Sk, Dh)),
            "wq": _w((lambda *s: torch.randn(*s, dtype=torch.bfloat16) * 0.8)(D, Hq * Dh) * (D ** -0.5)),
            "wo": _w((lambda *s: torch.randn(*s, dtype=torch.bfloat16) * 0.8)(Hq * Dh, D) * ((Hq * Dh) ** -0.5)),
        }
    _A_in = _A_setup()

    def _B_setup():
        B, S, D, F = 1, 1, 576, 4608
        return {
            "x": _w((lambda *s: torch.randn(*s, dtype=torch.bfloat16) * 0.05)(B, S, D)),
            "w_gate": _w((lambda *s: torch.randn(*s, dtype=torch.bfloat16) * 0.2)(D, F) * (D ** -0.5)),
            "w_up": _w((lambda *s: torch.randn(*s, dtype=torch.bfloat16) * 0.2)(D, F) * (D ** -0.5)),
            "w_down": _w((lambda *s: torch.randn(*s, dtype=torch.bfloat16) * 0.2)(F, D) * (F ** -0.5)),
        }
    _B_in = _B_setup()

    return {
        "A_x": _A_in["x"],
        "A_k_cache": _A_in["k_cache"],
        "A_v_cache": _A_in["v_cache"],
        "A_wq": _A_in["wq"],
        "A_wo": _A_in["wo"],
        "B_x": _B_in["x"],
        "B_w_gate": _B_in["w_gate"],
        "B_w_up": _B_in["w_up"],
        "B_w_down": _B_in["w_down"],
    }

def reference(A_x, A_k_cache, A_v_cache, A_wq, A_wo, B_x, B_w_gate, B_w_up, B_w_down):
    def _A_ref(x, k_cache, v_cache, wq, wo):
        B, Sq, D = x.shape
        Hq, Dh = 32, 128
        Hkv, Sk = k_cache.shape[1], k_cache.shape[2]
        W = min(4096, max(256, Sk // 4))
        rep = Hq // Hkv
        q = (lambda x, *d: x.permute(*d))((x @ wq).reshape(B, Sq, Hq, Dh), 0, 2, 1, 3)
        k = (lambda x, n, axis: torch.repeat_interleave(x, n, dim=axis))(k_cache[:, :, Sk - W:, :], rep, axis=1)
        v = (lambda x, n, axis: torch.repeat_interleave(x, n, dim=axis))(v_cache[:, :, Sk - W:, :], rep, axis=1)
        scores = torch.einsum("bhqd,bhkd->bhqk", q, k) * (Dh ** -0.5)
        p = _softmax(scores, axis=-1)
        o = torch.einsum("bhqk,bhkd->bhqd", p, v)
        return (lambda x, *d: x.permute(*d))(o, 0, 2, 1, 3).reshape(B, Sq, Hq * Dh) @ wo

    def _B_ref(x, w_gate, w_up, w_down):
        g = torch.einsum("bsd,df->bsf", x, w_gate)
        u = torch.einsum("bsd,df->bsf", x, w_up)
        h = g * u
        return torch.einsum("bsf,fd->bsd", h, w_down)

    x = A_x
    x = x + _A_ref(_layernorm(x, axis=-1), A_k_cache, A_v_cache, A_wq, A_wo)
    x = x + _B_ref(_layernorm(x, axis=-1), B_w_gate, B_w_up, B_w_down)
    x = x + _A_ref(_layernorm(x, axis=-1), A_k_cache, A_v_cache, A_wq, A_wo)
    x = x + _B_ref(_layernorm(x, axis=-1), B_w_gate, B_w_up, B_w_down)
    return x
```

```asm
; @launch grid=(256,1,1) block=(256,1,1) lds=158976
.amdgcn_target "amdgcn-amd-amdhsa--gfx950"
.text
.globl interleave_layers__sliding_block_cached__glu_gated_bilinear__decode_kernel
.p2align 8
.type interleave_layers__sliding_block_cached__glu_gated_bilinear__decode_kernel,@function
interleave_layers__sliding_block_cached__glu_gated_bilinear__decode_kernel:
    s_cmp_ge_u32 s2, 256
    s_cbranch_scc1 END
    s_load_dwordx16 s[4:19], s[0:1], 0
    s_load_dwordx8 s[20:27], s[0:1], 64
    v_lshrrev_b32 v4, 6, v0
    v_and_b32 v1, 63, v0
    v_readfirstlane_b32 s76, v4
    s_and_b32 s93, s2, 7
    s_lshl_b32 s93, s93, 1
    s_bfe_u32 s94, s2, 0x10003
    s_add_u32 s77, s93, s94
    s_lshr_b32 s78, s2, 4
    s_lshl_b32 s79, s2, 9
    s_and_b32 s79, s79, 0xf000
    s_mov_b32 s83, 0
    v_lshrrev_b32 v2, 4, v1
    v_and_b32 v3, 15, v1
    v_lshrrev_b32 v4, 3, v1
    v_and_b32 v5, 7, v1
    v_lshlrev_b32 v4, 13, v4
    v_lshl_add_u32 v4, v5, 4, v4
    s_lshl_b32 s93, s76, 7
    v_add_u32 v226, s93, v4
    s_lshl_b32 s93, s76, 10
    v_lshl_add_u32 v4, v2, 8, s93
    v_xor_b32 v5, v3, v2
    v_lshl_add_u32 v221, v5, 4, v4
    v_xor_b32 v222, 64, v221
    v_xor_b32 v223, 128, v221
    v_xor_b32 v224, 192, v221
    v_lshlrev_b32 v5, 2, v2
    v_xor_b32 v5, v3, v5
    v_lshl_add_u32 v225, v5, 4, v4
    v_lshlrev_b32 v6, 4, v1
    s_mul_i32 s96, s78, 72
    v_lshl_add_u32 v7, v3, 3, s96
    s_mul_i32 s93, s78, 294912
    s_lshl_b32 s94, s77, 9
    s_add_u32 s93, s93, s94
    s_lshl_b32 s95, s77, 23
    s_lshl_b32 s96, s78, 16
    s_add_u32 s95, s95, s96
    s_add_u32 s95, s95, 7340032
    s_mul_i32 s94, s76, 4608
    s_cmp_lg_u32 s76, 3
    s_waitcnt lgkmcnt(0)
    s_cbranch_scc1 NOX
    s_mov_b32 s56, s4
    s_and_b32 s57, s5, 0xffff
    s_mov_b32 s58, 0x480
    s_mov_b32 s59, 0x20000
    buffer_load_dwordx4 v[128:131], v6, s[56:59], 0 offen
    buffer_load_dwordx4 v[132:135], v6, s[56:59], 0 offen offset:1024
    buffer_load_dwordx2 v[136:137], v7, s[56:59], 0 offen
NOX:
    s_load_dword s97, s[26:27], 0
    s_add_u32 s36, s10, s93
    s_addc_u32 s37, s11, 0
    s_and_b32 s37, s37, 0xffff
    s_mov_b32 s38, 0x46200
    s_mov_b32 s39, 0x20000
    s_add_u32 m0, s94, 138240
    s_mov_b32 s93, 0
    buffer_load_dwordx4 v226, s[36:39], s93 offen nt lds
    s_add_u32 m0, s94, 139264
    s_mov_b32 s93, 65536
    buffer_load_dwordx4 v226, s[36:39], s93 offen nt lds
    s_add_u32 m0, s94, 140288
    s_mov_b32 s93, 131072
    buffer_load_dwordx4 v226, s[36:39], s93 offen nt lds
    s_add_u32 m0, s94, 141312
    s_mov_b32 s93, 196608
    buffer_load_dwordx4 v226, s[36:39], s93 offen nt lds
    s_add_u32 m0, s94, 142336
    s_mov_b32 s93, 262144
    s_mov_b32 exec_hi, 0
    buffer_load_dwordx4 v226, s[36:39], s93 offen nt lds
    s_mov_b32 exec_hi, -1
    s_add_u32 s28, s6, s95
    s_addc_u32 s29, s7, 0
    s_and_b32 s29, s29, 0xffff
    s_mov_b32 s30, 0x10000
    s_mov_b32 s31, 0x20000
    s_getpc_b64 s[100:101]
PCREF:
    s_lshl_b32 s93, s76, 12
    v_lshl_add_u32 v6, v1, 6, s93
    s_cmp_lt_u32 s2, 16
    s_cselect_b32 s93, CODE_END-PCREF-4, 0
    v_min_u32 v6, s93, v6
    global_load_dword v241, v6, s[100:101]
    s_lshl_b32 s94, s76, 14
    s_add_u32 m0, s94, 0
    s_add_u32 s93, s79, 0
    s_and_b32 s93, s93, 0xf000
    buffer_load_dwordx4 v221, s[28:31], s93 offen nt lds
    s_add_u32 m0, s94, 1024
    s_add_u32 s93, s79, 4096
    s_and_b32 s93, s93, 0xf000
    buffer_load_dwordx4 v222, s[28:31], s93 offen nt lds
    s_add_u32 m0, s94, 2048
    s_add_u32 s93, s79, 8192
    s_and_b32 s93, s93, 0xf000
    buffer_load_dwordx4 v223, s[28:31], s93 offen nt lds
    s_add_u32 m0, s94, 3072
    s_add_u32 s93, s79, 12288
    s_and_b32 s93, s93, 0xf000
    buffer_load_dwordx4 v224, s[28:31], s93 offen nt lds
    s_add_u32 m0, s94, 4096
    s_add_u32 s93, s79, 16384
    s_and_b32 s93, s93, 0xf000
    buffer_load_dwordx4 v221, s[28:31], s93 offen nt lds
    s_add_u32 s32, s8, s95
    s_addc_u32 s33, s9, 0
    s_and_b32 s33, s33, 0xffff
    s_mov_b32 s34, 0x10000
    s_mov_b32 s35, 0x20000
    s_mov_b32 s64, s26
    s_and_b32 s65, s27, 0xffff
    s_mov_b32 s66, 0x2a0000
    s_mov_b32 s67, 0x20000
    s_mov_b32 s68, s26
    s_and_b32 s69, s27, 0xffff
    s_mov_b32 s70, 0x0
    s_mov_b32 s71, 0x20000
    s_mov_b32 s72, s26
    s_and_b32 s73, s27, 0xffff
    s_mov_b32 s74, 0x2a0000
    s_mov_b32 s75, 0x20000
    s_mov_b32 s5, 0x3ae38e39
    s_mov_b32 s6, 0xffff0000
    s_getreg_b32 s85, hwreg(HW_REG_XCC_ID)
    s_and_b32 s85, s85, 15
    s_mov_b32 s98, 0x01ff01ff
    s_mov_b32 s99, 0x01ff01ff
    v_mov_b32 v108, 0x3f803f80
    v_mov_b32 v109, 0x3f803f80
    v_mov_b32 v66, s85
    v_mov_b32 v11, 0x80000000
    s_mov_b32 s95, 132992
    v_lshl_add_u32 v10, v1, 4, s95
    v_lshrrev_b32 v4, 2, v1
    s_mov_b32 s93, 131072
    v_lshl_add_u32 v5, v4, 3, s93
    v_mov_b32 v6, 131200
    s_mov_b32 vcc_lo, 0x22222222
    s_mov_b32 vcc_hi, 0x22222222
    v_cndmask_b32 v12, v5, v6, vcc
    ds_write_b64 v6, v[108:109]
    v_lshl_add_u32 v4, v3, 3, s93
    s_mov_b64 vcc, 0xffff
    v_cndmask_b32 v28, v10, v4, vcc
    s_lshl_b32 s93, s77, 14
    s_lshl_b32 s95, s76, 8
    s_add_u32 s93, s93, s95
    s_add_u32 s93, s93, 0x1000
    v_lshl_add_u32 v4, v2, 12, s93
    v_lshl_add_u32 v14, v3, 4, v4
    s_lshl_b32 s96, s78, 10
    s_add_u32 s93, s93, s96
    v_lshl_add_u32 v13, v1, 2, s93
    s_lshl_b32 s93, s77, 8
    s_add_u32 s93, s93, 0x181000
    v_lshl_add_u32 v15, v3, 4, s93
    s_lshl_b32 s96, s78, 4
    s_add_u32 s93, s93, s96
    v_mov_b32 v4, s93
    v_cmp_eq_u32 vcc, 192, v0
    v_lshrrev_b32 v5, 2, v3
    v_lshlrev_b32 v5, 7, v5
    v_cndmask_b32 v16, v11, v4, vcc
    v_lshl_add_u32 v5, v2, 5, v5
    v_and_b32 v6, 3, v1
    v_lshl_add_u32 v5, v6, 3, v5
    s_mul_i32 s93, s76, 4608
    s_add_u32 s93, s93, 138240
    v_add_u32 v227, s93, v5
    s_lshl_b32 s96, s78, 4
    s_lshl_b32 s93, s77, 9
    s_lshr_b32 s95, s76, 1
    s_lshl_b32 s95, s95, 8
    s_add_u32 s93, s93, s95
    s_add_u32 s93, s93, 0x183000
    v_lshl_add_u32 v4, v2, 2, v3
    v_and_b32 v4, 15, v4
    v_lshl_add_u32 v17, v4, 4, s93
    s_add_u32 s93, s93, s96
    v_mov_b32 v4, s93
    v_and_b32 v5, 127, v0
    v_cmp_eq_u32 vcc, 0, v5
    s_nop 0
    s_nop 0
    v_cndmask_b32 v18, v11, v4, vcc
    s_lshr_b32 s93, s78, 1
    s_lshl_b32 s93, s93, 14
    s_and_b32 s95, s78, 1
    s_lshl_b32 s95, s95, 12
    s_add_u32 s93, s93, s95
    s_add_u32 s93, s93, 0x200000
    s_lshr_b32 s95, s85, 2
    s_and_b32 s95, s95, 1
    s_xor_b32 s95, s95, 1
    s_lshl_b32 s95, s95, 13
    s_and_b32 s95, s95, 8192
    s_add_u32 s95, s95, s93
    v_min_u32 v4, 8, v3
    v_mul_u32_u24 v5, 43, v4
    v_lshrrev_b32 v5, 7, v5
    v_add_u32 v4, v4, v5
    v_lshl_add_u32 v5, v2, 10, s95
    v_lshl_add_u32 v27, v4, 4, v5
    s_lshl_b32 s96, s77, 8
    s_add_u32 s95, s95, s96
    s_add_u32 s95, s95, 0x80000
    v_mov_b32 v239, s95
    s_lshl_b32 s95, s77, 8
    s_add_u32 s93, s93, s95
    s_lshl_b32 s95, s76, 6
    s_add_u32 s95, s93, s95
    v_lshl_add_u32 v4, v3, 2, s95
    v_lshl_add_u32 v4, v2, 13, v4
    s_mov_b32 vcc_lo, 0xfff0fff
    s_mov_b32 vcc_hi, 0
    v_cndmask_b32 v26, v11, v4, vcc
    s_and_b32 s95, s76, 1
    s_xor_b32 s95, s95, 1
    s_lshl_b32 s95, s95, 13
    s_add_u32 s95, s95, s93
    v_lshl_add_u32 v4, v2, 17, s95
    v_lshl_add_u32 v4, v3, 4, v4
    v_cmp_le_u32 vcc, 128, v0
    v_mov_b32 v148, 0
    v_mov_b32 v149, 0
    v_mov_b32 v150, 0
    v_mov_b32 v151, 0
    v_cndmask_b32 v4, v11, v4, vcc
    buffer_store_dwordx4 v[148:151], v4, s[64:67], 0 offen sc1
    s_mov_b64 vcc, 0xff
    s_mov_b32 s95, 0x80000
    v_cndmask_b32 v4, v11, v4, vcc
    buffer_store_dwordx4 v[148:151], v4, s[64:67], s95 offen sc1
    s_lshl_b32 s93, s77, 4
    s_add_u32 s93, s93, s78
    s_mul_i32 s95, s93, 1536
    s_add_u32 s95, s95, 788480
    v_lshl_add_u32 v4, v1, 7, s95
    v_add_u32 v5, 391680, v4
    v_cmp_gt_u32 vcc, 28, v1
    s_lshl_b32 s95, s93, 10
    s_add_u32 s95, s95, 528384
    v_cndmask_b32 v4, v5, v4, vcc
    v_lshl_add_u32 v5, v1, 7, s95
    s_mov_b64 vcc, 0xff
    v_cndmask_b32 v4, v4, v5, vcc
    v_add_u32 v5, 0xfffbfc00, v5
    s_mov_b64 vcc, 0xff00
    v_cndmask_b32 v4, v4, v5, vcc
    s_lshl_b32 s95, s77, 8
    s_add_u32 s95, s95, 1579776
    v_lshl_add_u32 v5, v1, 5, s95
    s_mov_b32 vcc_lo, 0
    s_mov_b32 vcc_hi, 0xff00
    v_cndmask_b32 v4, v4, v5, vcc
    s_mov_b32 vcc_hi, 0xffff0000
    v_cndmask_b32 v4, v4, v17, vcc
    v_cmp_eq_u32 vcc, s76, v2
    s_nop 0
    s_and_b32 vcc_lo, vcc_lo, -1
    s_and_b32 vcc_hi, vcc_hi, -1
    s_or_b32 vcc_hi, vcc_hi, 0x01010000
    v_cndmask_b32 v4, v11, v4, vcc
    buffer_load_dword v241, v4, s[64:67], 0 offen sc1
    s_add_u32 m0, s94, 5120
    s_add_u32 s93, s79, 20480
    s_and_b32 s93, s93, 0xf000
    buffer_load_dwordx4 v222, s[28:31], s93 offen nt lds
    s_add_u32 m0, s94, 6144
    s_add_u32 s93, s79, 24576
    s_and_b32 s93, s93, 0xf000
    buffer_load_dwordx4 v223, s[28:31], s93 offen nt lds
    s_add_u32 m0, s94, 7168
    s_add_u32 s93, s79, 28672
    s_and_b32 s93, s93, 0xf000
    buffer_load_dwordx4 v224, s[28:31], s93 offen nt lds
    s_add_u32 m0, s94, 8192
    s_add_u32 s93, s79, 32768
    s_and_b32 s93, s93, 0xf000
    buffer_load_dwordx4 v221, s[28:31], s93 offen nt lds
    s_add_u32 m0, s94, 9216
    s_add_u32 s93, s79, 36864
    s_and_b32 s93, s93, 0xf000
    buffer_load_dwordx4 v222, s[28:31], s93 offen nt lds
    s_waitcnt lgkmcnt(0)
    s_mov_b32 s80, s97
    s_and_b32 s80, s80, 0x1fff1fff
    s_add_u32 s80, s80, 0x10001
    s_and_b32 s80, s80, 0x1fff1fff
    s_or_b32 s80, s80, 0x20002000
    s_lshr_b32 s81, s80, 16
    s_lshl_b32 s82, s80, 16
    s_and_b32 s93, s80, 0xffff0000
    v_mov_b32 v4, s82
    v_mov_b32 v5, s93
    s_mov_b32 vcc_lo, 0x55555555
    s_mov_b32 vcc_hi, 0x55555555
    v_cndmask_b32 v53, v5, v4, vcc
    s_mov_b32 vcc_lo, 0x0f0f0f0f
    s_mov_b32 vcc_hi, 0x0f0f0f0f
    v_cndmask_b32 v54, v5, v4, vcc
    v_mov_b32 v67, s80
    v_mov_b32 v71, s80
    s_mov_b32 s10, s80
    s_mov_b32 s14, s81
    v_mov_b32 v76, v53
    s_cmp_lg_u32 s76, 3
    s_cbranch_scc1 Q_ENTRY
    s_waitcnt vmcnt(19)
    v_mov_b32 v4, 0
    v_dot2c_f32_bf16 v4, v128, v108
    v_dot2c_f32_bf16 v4, v129, v108
    v_dot2c_f32_bf16 v4, v130, v108
    v_dot2c_f32_bf16 v4, v131, v108
    v_dot2c_f32_bf16 v4, v132, v108
    v_dot2c_f32_bf16 v4, v133, v108
    v_dot2c_f32_bf16 v4, v134, v108
    v_dot2c_f32_bf16 v4, v135, v108
    v_lshlrev_b32 v180, 16, v136
    v_and_b32 v181, s6, v136
    v_lshlrev_b32 v182, 16, v137
    v_and_b32 v183, s6, v137
    v_add_f32_dpp v4, v4, v4 row_ror:8 row_mask:0xf bank_mask:0xf
    s_nop 1
    v_add_f32_dpp v4, v4, v4 row_ror:4 row_mask:0xf bank_mask:0xf
    s_nop 1
    v_add_f32_dpp v4, v4, v4 row_ror:2 row_mask:0xf bank_mask:0xf
    s_nop 1
    v_add_f32_dpp v4, v4, v4 row_ror:1 row_mask:0xf bank_mask:0xf
    s_nop 1
    v_add_f32_dpp v4, v4, v4 row_bcast:15 row_mask:0xa bank_mask:0xf
    s_nop 1
    v_add_f32_dpp v4, v4, v4 row_bcast:31 row_mask:0xc bank_mask:0xf
    s_nop 0
    v_readlane_b32 s93, v4, 63
    s_nop 1
    v_mov_b32 v4, s93
    v_mul_f32 v56, s5, v4
    v_sub_f32 v180, v180, v56
    v_sub_f32 v181, v181, v56
    v_sub_f32 v182, v182, v56
    v_sub_f32 v183, v183, v56
    v_cvt_pk_bf16_f32 v200, v180, v181
    v_cvt_pk_bf16_f32 v201, v182, v183
    ds_write_b64 v28, v[200:201]
    s_branch Q_WAIT
W3_E:
    s_waitcnt lgkmcnt(0)
    s_barrier
    s_cmp_lg_u32 s83, 0
    s_cbranch_scc1 W3_E1
    v_xor_b32 v6, 0x2000, v239
    s_waitcnt vmcnt(0)
    buffer_load_dword v241, v239, s[64:67], 0 offen sc1
    buffer_load_dword v241, v6, s[64:67], 0 offen sc1
    buffer_load_dwordx4 v[156:159], v14, s[64:67], s86 offen sc1
    buffer_load_dwordx4 v[160:163], v14, s[64:67], s86 offen offset:1024 sc1
    buffer_load_dwordx4 v[164:167], v14, s[64:67], s86 offen offset:2048 sc1
    buffer_load_dwordx4 v[168:171], v14, s[64:67], s86 offen offset:3072 sc1
    s_waitcnt vmcnt(5)
    v_add_f32 v56, v56, v216
    v_sub_f32 v188, v184, v56
    v_sub_f32 v189, v185, v56
    v_sub_f32 v190, v186, v56
    v_sub_f32 v191, v187, v56
    s_and_b32 s80, s80, 0x1fff1fff
    s_add_u32 s80, s80, 0x10001
    s_and_b32 s80, s80, 0x1fff1fff
    s_or_b32 s80, s80, 0x20002000
    s_lshr_b32 s81, s80, 16
    s_lshl_b32 s82, s80, 16
    s_and_b32 s93, s80, 0xffff0000
    v_mov_b32 v4, s82
    v_mov_b32 v5, s93
    s_mov_b32 vcc_lo, 0x55555555
    s_mov_b32 vcc_hi, 0x55555555
    v_cndmask_b32 v53, v5, v4, vcc
    s_mov_b32 vcc_lo, 0x0f0f0f0f
    s_mov_b32 vcc_hi, 0x0f0f0f0f
    v_cndmask_b32 v54, v5, v4, vcc
    v_mov_b32 v67, s80
    v_mov_b32 v71, s80
    s_getreg_b32 s93, hwreg(HW_REG_IB_STS, 0, 4)
    s_cmp_eq_u32 s93, 5
    s_cselect_b32 s93, 0, 0x2000
    v_xor_b32 v27, s93, v27
    s_waitcnt vmcnt(0)
CHECK_CR:
    v_mfma_f32_16x16x32_bf16 v[120:123], v[36:39], v[156:159], 0
    v_bitop3_b32 v4, v156, v158, s10 bitop3:0x7e
    v_bitop3_b32 v5, v157, v159, s14 bitop3:0x7e
    v_or_b32 v220, v4, v5
    v_mfma_f32_16x16x32_bf16 v[120:123], v[36:39], v[160:163], v[120:123]
    v_bitop3_b32 v4, v160, v162, s10 bitop3:0x7e
    v_bitop3_b32 v5, v161, v163, s14 bitop3:0x7e
    v_or3_b32 v220, v4, v5, v220
    v_mfma_f32_16x16x32_bf16 v[120:123], v[36:39], v[164:167], v[120:123]
    v_bitop3_b32 v4, v164, v166, s10 bitop3:0x7e
    v_bitop3_b32 v5, v165, v167, s14 bitop3:0x7e
    v_or3_b32 v220, v4, v5, v220
    v_mfma_f32_16x16x32_bf16 v[120:123], v[36:39], v[168:171], v[120:123]
    v_bitop3_b32 v4, v168, v170, s10 bitop3:0x7e
    v_bitop3_b32 v5, v169, v171, s14 bitop3:0x7e
    v_or3_b32 v220, v4, v5, v220
    v_cmp_ne_u16 vcc, 0, v220
    s_nop 0
    s_cmp_lg_u64 vcc, 0
    s_cbranch_scc1 RETRY_CR
CONT_CR:
    s_nop 0
    v_mov_b32 v192, v120
    s_barrier
    s_branch W3_E2
W3_E1:
    v_add_f32 v56, v56, v216
    v_sub_f32 v188, v184, v56
    v_sub_f32 v189, v185, v56
    v_sub_f32 v190, v186, v56
    v_sub_f32 v191, v187, v56
    s_barrier
    s_cmp_lg_u32 s77, s78
    s_cbranch_scc1 FINISH
W3_E2:
GX_ISSUE_E:
    buffer_load_dwordx4 v[128:131], v27, s[64:67], s90 offen sc1
    buffer_load_dwordx4 v[132:135], v27, s[64:67], s90 offen offset:256 sc1
    buffer_load_dwordx4 v[136:139], v27, s[64:67], s90 offen offset:512 sc1
    buffer_load_dwordx4 v[140:143], v27, s[64:67], s90 offen offset:768 sc1
    s_waitcnt vmcnt(3)
    v_mfma_f32_16x16x32_bf16 v[180:183], v[44:47], v[128:131], v[188:191]
    v_bitop3_b32 v4, v128, v130, s10 bitop3:0x7e
    v_bitop3_b32 v5, v129, v131, s14 bitop3:0x7e
    v_or_b32 v220, v4, v5
    s_waitcnt vmcnt(2)
    v_mfma_f32_16x16x32_bf16 v[180:183], v[44:47], v[132:135], v[180:183]
    v_bitop3_b32 v4, v132, v134, s10 bitop3:0x7e
    v_bitop3_b32 v5, v133, v135, s14 bitop3:0x7e
    v_or3_b32 v220, v4, v5, v220
    s_waitcnt vmcnt(1)
    v_mfma_f32_16x16x32_bf16 v[180:183], v[44:47], v[136:139], v[180:183]
    v_bitop3_b32 v4, v136, v138, s10 bitop3:0x7e
    v_bitop3_b32 v5, v137, v139, s14 bitop3:0x7e
    v_or3_b32 v220, v4, v5, v220
    s_waitcnt vmcnt(0)
    v_mfma_f32_16x16x32_bf16 v[180:183], v[44:47], v[140:143], v[180:183]
    v_bitop3_b32 v4, v140, v142, s10 bitop3:0x7e
    v_bitop3_b32 v5, v141, v143, s14 bitop3:0x7e
    v_or3_b32 v220, v4, v5, v220
    v_cmp_ne_u16 vcc, 0, v220
    s_nop 0
    s_cmp_lg_u64 vcc, 0
    s_cbranch_scc1 RETRY_E
CONT_E:
    s_cmp_lg_u32 s83, 0
    s_cbranch_scc1 W3_OUT
    v_cvt_pk_bf16_f32 v200, v180, v181
    v_cvt_pk_bf16_f32 v201, v182, v183
    ds_write_b64 v28, v[200:201]
    s_add_u32 s90, s90, 0x20000
    s_mov_b32 s62, 1152
    s_mov_b32 s83, 1
Q_WAIT:
    v_add_f32 v8, v180, v181
    v_mul_f32 v9, v180, v180
    v_add_f32 v57, v182, v183
    v_fmac_f32 v9, v181, v181
    v_add_f32 v8, v8, v57
    v_fmac_f32 v9, v182, v182
    v_cndmask_b32 v64, 0, v8, s[98:99]
    v_fmac_f32 v9, v183, v183
    v_cndmask_b32 v65, 0, v9, s[98:99]
    s_waitcnt lgkmcnt(0)
    s_barrier
    ds_read_b64 v[100:101], v12
    v_add_f32_dpp v64, v64, v64 row_ror:8 row_mask:0xf bank_mask:0xf
    v_add_f32_dpp v65, v65, v65 row_ror:8 row_mask:0xf bank_mask:0xf
    s_nop 0
    v_add_f32_dpp v64, v64, v64 row_ror:4 row_mask:0xf bank_mask:0xf
    v_add_f32_dpp v65, v65, v65 row_ror:4 row_mask:0xf bank_mask:0xf
    s_nop 0
    v_add_f32_dpp v64, v64, v64 row_ror:2 row_mask:0xf bank_mask:0xf
    v_add_f32_dpp v65, v65, v65 row_ror:2 row_mask:0xf bank_mask:0xf
    s_nop 0
    v_add_f32_dpp v64, v64, v64 row_ror:1 row_mask:0xf bank_mask:0xf
    v_add_f32_dpp v65, v65, v65 row_ror:1 row_mask:0xf bank_mask:0xf
    buffer_store_dwordx4 v[64:67], v16, s[68:71], 0 offen
Q_JOIN:
    s_cmp_eq_u32 s83, 0
    s_cbranch_scc1 L1_WQ
BACK_WQ:
    s_waitcnt lgkmcnt(0)
    v_mfma_f32_4x4x4_16b_bf16 v[112:115], v[100:101], v[82:83], 0 cbsz:4 abid:0
    v_mfma_f32_4x4x4_16b_bf16 v[116:119], v[100:101], v[84:85], 0 cbsz:4 abid:1
    v_mfma_f32_4x4x4_16b_bf16 v[120:123], v[100:101], v[86:87], 0 cbsz:4 abid:2
    v_mfma_f32_4x4x4_16b_bf16 v[112:115], v[100:101], v[88:89], v[112:115] cbsz:4 abid:3
    v_mfma_f32_4x4x4_16b_bf16 v[116:119], v[100:101], v[90:91], v[116:119] cbsz:4 abid:4
    v_mfma_f32_4x4x4_16b_bf16 v[120:123], v[100:101], v[92:93], v[120:123] cbsz:4 abid:5
    v_mfma_f32_4x4x4_16b_bf16 v[112:115], v[100:101], v[94:95], v[112:115] cbsz:4 abid:6
    v_mfma_f32_4x4x4_16b_bf16 v[116:119], v[100:101], v[96:97], v[116:119] cbsz:4 abid:7
    v_mfma_f32_4x4x4_16b_bf16 v[120:123], v[100:101], v[98:99], v[120:123] cbsz:4 abid:8
    s_nop 3
    v_pk_add_f32 v[198:199], v[112:113], v[116:117]
    v_pk_add_f32 v[198:199], v[198:199], v[120:121]
    v_cvt_pk_bf16_f32 v6, v53, v198
    buffer_store_dword v6, v13, s[68:71], 0 offen
    buffer_store_dword v6, v13, s[72:75], 0 offen sc1
    buffer_store_dwordx4 v[64:67], v16, s[72:75], 0 offen sc1
    v_add_f32 v184, v180, v56
    v_add_f32 v185, v181, v56
    v_add_f32 v186, v182, v56
    v_add_f32 v187, v183, v56
    v_cvt_pk_bf16_f32 v185, v184, v185
    v_cvt_pk_bf16_f32 v187, v186, v187
    v_lshlrev_b32 v184, 16, v185
    v_lshlrev_b32 v186, 16, v187
    v_and_b32 v185, s6, v185
    v_and_b32 v187, s6, v187
    s_cmp_lg_u32 s83, 0
    s_cbranch_scc1 GA_PRE
    v_cvt_pk_bf16_f32 v238, v53, v199
    s_lshl_b32 s94, s76, 14
    s_add_u32 m0, s94, 10240
    s_add_u32 s93, s79, 40960
    s_and_b32 s93, s93, 0xf000
    buffer_load_dwordx4 v223, s[28:31], s93 offen nt lds
    s_add_u32 m0, s94, 11264
    s_add_u32 s93, s79, 45056
    s_and_b32 s93, s93, 0xf000
    buffer_load_dwordx4 v224, s[28:31], s93 offen nt lds
    s_add_u32 m0, s94, 12288
    s_add_u32 s93, s79, 49152
    s_and_b32 s93, s93, 0xf000
    buffer_load_dwordx4 v221, s[28:31], s93 offen nt lds
    s_add_u32 m0, s94, 13312
    s_add_u32 s93, s79, 53248
    s_and_b32 s93, s93, 0xf000
    buffer_load_dwordx4 v222, s[28:31], s93 offen nt lds
    s_add_u32 m0, s94, 14336
    s_add_u32 s93, s79, 57344
    s_and_b32 s93, s93, 0xf000
    buffer_load_dwordx4 v223, s[28:31], s93 offen nt lds
    s_add_u32 m0, s94, 15360
    s_add_u32 s93, s79, 61440
    s_and_b32 s93, s93, 0xf000
    buffer_load_dwordx4 v224, s[28:31], s93 offen nt lds
    s_add_u32 m0, s94, 65536
    s_add_u32 s93, s79, 0
    s_and_b32 s93, s93, 0xf000
    buffer_load_dwordx4 v225, s[32:35], s93 offen nt lds
    s_add_u32 m0, s94, 66560
    s_add_u32 s93, s79, 4096
    s_and_b32 s93, s93, 0xf000
    buffer_load_dwordx4 v225, s[32:35], s93 offen nt lds
    s_add_u32 m0, s94, 67584
    s_add_u32 s93, s79, 8192
    s_and_b32 s93, s93, 0xf000
    buffer_load_dwordx4 v225, s[32:35], s93 offen nt lds
    s_add_u32 m0, s94, 68608
    s_add_u32 s93, s79, 12288
    s_and_b32 s93, s93, 0xf000
    buffer_load_dwordx4 v225, s[32:35], s93 offen nt lds
    s_mul_i32 s93, s77, 294912
    s_mul_i32 s95, s78, 72
    s_and_b32 s95, s95, 0xfffffff0
    s_add_u32 s93, s93, s95
    s_add_u32 s40, s12, s93
    s_addc_u32 s41, s13, 0
    s_and_b32 s41, s41, 0xffff
    s_mov_b32 s42, 0x47bd0
    s_mov_b32 s43, 0x20000
    s_mul_i32 s93, s77, 331776
    s_add_u32 s93, s93, s95
    s_add_u32 s52, s20, s93
    s_addc_u32 s53, s21, 0
    s_and_b32 s53, s53, 0xffff
    s_mov_b32 s54, 0x50bd0
    s_mov_b32 s55, 0x20000
    s_mul_i32 s93, s78, 331776
    s_mul_i32 s95, s77, 576
    s_add_u32 s93, s93, s95
    s_add_u32 s44, s16, s93
    s_addc_u32 s45, s17, 0
    s_and_b32 s45, s45, 0xffff
    s_mov_b32 s46, 0x4ee40
    s_mov_b32 s47, 0x20000
    s_add_u32 s48, s18, s93
    s_addc_u32 s49, s19, 0
    s_and_b32 s49, s49, 0xffff
    s_mov_b32 s50, 0x4ee40
    s_mov_b32 s51, 0x20000
    s_mov_b32 s60, s22
    s_and_b32 s61, s23, 0xffff
    s_mov_b32 s62, 0x0
    s_mov_b32 s63, 0x20000
    s_mov_b32 s86, 0x40000
    s_mov_b32 s87, 0x80000
    s_mov_b32 s88, 0x1000
    s_mov_b32 s89, 0x60000
    s_mov_b32 s90, 0
    s_mov_b32 s4, 0x3e0293ee
    s_mov_b32 s84, 200000
    s_mov_b32 s15, 0xffff
    s_mov_b32 s12, 0
    v_mov_b32 v55, 0x3727c5ac
    v_mov_b32 v70, 0
    v_mov_b32 v192, 0
    v_mov_b32 v4, 0xffff0000
    v_mov_b32 v5, 0x3f800000
    v_mov_b32 v6, 0x3f80
    s_mov_b32 vcc_lo, 0x10001
    s_mov_b32 vcc_hi, 0x10001
    v_cndmask_b32 v40, 0, v4, vcc
    v_cndmask_b32 v36, 0, v5, vcc
    s_mov_b32 vcc_lo, 0x10001
    s_mov_b32 vcc_hi, 0x10001
    v_cndmask_b32 v44, 0, v5, vcc
    s_mov_b32 vcc_lo, 0x100010
    s_mov_b32 vcc_hi, 0x100010
    v_cndmask_b32 v41, 0, v4, vcc
    v_cndmask_b32 v37, 0, v5, vcc
    s_mov_b32 vcc_lo, 0x20002
    s_mov_b32 vcc_hi, 0x20002
    v_cndmask_b32 v45, 0, v5, vcc
    s_mov_b32 vcc_lo, 0x1000100
    s_mov_b32 vcc_hi, 0x1000100
    v_cndmask_b32 v42, 0, v4, vcc
    v_cndmask_b32 v38, 0, v5, vcc
    s_mov_b32 vcc_lo, 0x40004
    s_mov_b32 vcc_hi, 0x40004
    v_cndmask_b32 v46, 0, v5, vcc
    s_mov_b32 vcc_lo, 0x10001000
    s_mov_b32 vcc_hi, 0x10001000
    v_cndmask_b32 v43, 0, v4, vcc
    v_cndmask_b32 v39, 0, v5, vcc
    s_mov_b32 vcc_lo, 0x80008
    s_mov_b32 vcc_hi, 0x80008
    v_cndmask_b32 v47, 0, v5, vcc
    s_mov_b32 vcc_lo, 0x10001
    s_mov_b32 vcc_hi, 0x10001
    v_cndmask_b32 v48, 0, v6, vcc
    s_mov_b32 vcc_lo, 0x20002
    s_mov_b32 vcc_hi, 0x20002
    v_cndmask_b32 v48, v48, v5, vcc
    s_mov_b32 vcc_lo, 0x1000100
    s_mov_b32 vcc_hi, 0x1000100
    v_cndmask_b32 v49, 0, v6, vcc
    s_mov_b32 vcc_lo, 0x100010
    s_mov_b32 vcc_hi, 0x100010
    v_cndmask_b32 v50, 0, v6, vcc
    s_mov_b32 vcc_lo, 0x200020
    s_mov_b32 vcc_hi, 0x200020
    v_cndmask_b32 v50, v50, v5, vcc
    s_mov_b32 vcc_lo, 0x2000200
    s_mov_b32 vcc_hi, 0x2000200
    v_cndmask_b32 v51, 0, v6, vcc
    v_mov_b32 v5, 0x03020706
    v_mov_b32 v6, 0x05040100
    s_mov_b32 vcc_lo, 0x55555555
    s_mov_b32 vcc_hi, 0x55555555
    v_cndmask_b32 v52, v5, v6, vcc
    v_mov_b32 v5, 0xeeee
    v_mov_b32 v6, 0x4444
    v_cndmask_b32 v77, v5, v6, vcc
    s_mov_b32 s93, 132800
    v_lshl_add_u32 v5, v2, 4, s93
    v_mov_b32 v6, 131216
    v_cndmask_b32 v79, v6, v5, vcc
    v_mov_b32 v148, 0
    v_mov_b32 v149, 0
    v_mov_b32 v150, 0
    v_mov_b32 v151, 0
    ds_write_b128 v6, v[148:151]
    v_and_b32 v5, 1, v1
    v_lshrrev_b32 v4, 2, v1
    v_lshlrev_b32 v4, 3, v4
    v_lshl_add_u32 v4, v5, 8, v4
    v_add_u32 v20, 131264, v4
    s_lshl_b32 s93, s76, 7
    s_add_u32 s93, s93, 131264
    v_lshl_add_u32 v4, v3, 2, v2
    v_lshl_add_u32 v19, v4, 1, s93
    s_lshl_b32 s93, s76, 8
    s_add_u32 s93, s93, 134144
    v_lshl_add_u32 v21, v1, 2, s93
    s_lshl_b32 s93, s76, 10
    s_add_u32 s93, s93, 134144
    v_lshl_add_u32 v22, v1, 2, s93
    s_lshl_b32 s93, s76, 2
    s_add_u32 s93, s93, 132928
    v_mov_b32 v4, s93
    s_mov_b32 s93, 132992
    v_lshl_add_u32 v5, v1, 2, s93
    s_mov_b32 vcc_lo, 0
    s_mov_b32 vcc_hi, 0x80000000
    v_cndmask_b32 v23, v5, v4, vcc
    s_lshr_b32 s93, s76, 1
    s_lshl_b32 s93, s93, 5
    s_add_u32 s93, s93, 132928
    v_mov_b32 v24, s93
    s_mov_b32 s93, 131776
    v_lshl_add_u32 v4, v2, 5, s93
    v_and_b32 v5, 1, v1
    v_lshl_add_u32 v25, v5, 4, v4
    s_lshl_b32 s93, s76, 7
    s_add_u32 s93, s93, 131776
    v_lshrrev_b32 v4, 2, v3
    v_lshl_add_u32 v4, v4, 5, s93
    v_lshrrev_b32 v5, 1, v2
    v_lshl_add_u32 v4, v5, 4, v4
    v_and_b32 v5, 3, v3
    v_lshl_add_u32 v4, v5, 2, v4
    v_and_b32 v5, 1, v2
    v_lshl_add_u32 v78, v5, 1, v4
    s_mul_i32 s93, s78, 72
    v_lshl_add_u32 v4, v3, 3, s93
    s_cmp_eq_u32 s76, 3
    s_cselect_b64 vcc, 0x1ff, 0
    v_cndmask_b32 v35, v11, v4, vcc
    s_mul_i32 s93, s77, 24576
    s_add_u32 s93, s93, 0xc1000
    s_mul_i32 s95, s78, 1536
    s_lshl_b32 s96, s76, 9
    s_add_u32 s95, s95, s96
    s_add_u32 s95, s95, s93
    v_lshrrev_b32 v4, 3, v1
    v_lshl_add_u32 v4, v4, 6, s95
    v_and_b32 v5, 3, v1
    v_lshl_add_u32 v4, v5, 4, v4
    v_and_b32 v5, 4, v1
    v_cmp_gt_u32 vcc, 192, v0
    v_lshl_add_u32 v4, v5, 1, v4
    s_mul_i32 s95, s76, 384
    v_cndmask_b32 v29, v11, v4, vcc
    s_add_u32 s93, s93, s95
    v_mul_u32_u24 v4, 6144, v2
    v_add_u32 v4, s93, v4
    v_lshl_add_u32 v30, v3, 4, v4
    v_add_u32 v31, 3072, v30
    v_lshrrev_b32 v5, 3, v3
    v_mul_u32_u24 v5, 3072, v5
    v_and_b32 v6, 7, v3
    v_lshl_add_u32 v5, v6, 4, v5
    v_add_u32 v4, v4, v5
    v_add_u32 v32, 256, v4
    s_mul_i32 s93, s76, 24
    s_add_u32 s95, s93, 0
    v_add_u32 v4, s95, v3
    v_lshrrev_b32 v5, 5, v4
    v_mul_u32_u24 v5, 96, v5
    v_and_b32 v4, 31, v4
    v_and_b32 v7, 28, v4
    v_add_u32 v7, v7, v4
    v_lshl_add_u32 v7, v2, 2, v7
    v_add_u32 v4, 64, v4
    s_mov_b32 vcc_lo, 0
    s_mov_b32 vcc_hi, 0xffff
    v_cndmask_b32 v4, v7, v4, vcc
    v_add_u32 v4, v4, v5
    v_and_b32 v5, 0x1f1, v4
    v_and_b32 v7, 2, v4
    v_lshl_or_b32 v5, v7, 2, v5
    v_bfe_u32 v7, v4, 2, 2
    v_lshl_or_b32 v5, v7, 1, v5
    v_cmp_gt_u32 vcc, 0x100, v4
    s_nop 1
    v_cndmask_b32 v4, v4, v5, vcc
    v_lshlrev_b32 v4, 1, v4
    v_add_u32 v4, 132288, v4
    s_mov_b32 vcc_lo, 0
    s_mov_b32 vcc_hi, 0xffff0000
    v_cndmask_b32 v33, v4, v10, vcc
    s_add_u32 s95, s93, 16
    v_add_u32 v4, s95, v6
    v_lshrrev_b32 v5, 5, v4
    v_mul_u32_u24 v5, 96, v5
    v_and_b32 v4, 31, v4
    v_and_b32 v7, 28, v4
    v_add_u32 v7, v7, v4
    v_lshl_add_u32 v7, v2, 2, v7
    v_add_u32 v4, 64, v4
    s_mov_b32 vcc_lo, 0
    s_mov_b32 vcc_hi, 0xffff
    v_cndmask_b32 v4, v7, v4, vcc
    v_add_u32 v4, v4, v5
    v_and_b32 v5, 0x1f1, v4
    v_and_b32 v7, 2, v4
    v_lshl_or_b32 v5, v7, 2, v5
    v_bfe_u32 v7, v4, 2, 2
    v_lshl_or_b32 v5, v7, 1, v5
    v_cmp_gt_u32 vcc, 0x100, v4
    s_nop 1
    v_cndmask_b32 v4, v4, v5, vcc
    v_lshlrev_b32 v4, 1, v4
    v_add_u32 v4, 132288, v4
    s_mov_b32 vcc_lo, 0
    s_mov_b32 vcc_hi, 0xffff0000
    v_cndmask_b32 v34, v4, v10, vcc
    s_mul_i32 s93, s76, 82944
    v_add_u32 v4, 0, v1
    v_mul_u32_u24 v5, 58255, v4
    v_lshrrev_b32 v5, 21, v5
    v_mul_u32_u24 v5, 8640, v5
    v_lshl_add_u32 v5, v4, 4, v5
    v_add_u32 v230, s93, v5
    v_add_u32 v4, 54, v1
    v_mul_u32_u24 v5, 58255, v4
    v_lshrrev_b32 v5, 21, v5
    v_mul_u32_u24 v5, 8640, v5
    v_lshl_add_u32 v5, v4, 4, v5
    v_add_u32 v231, s93, v5
    v_add_u32 v4, 0, v1
    v_mul_u32_u24 v5, 52429, v4
    v_lshrrev_b32 v5, 18, v5
    v_mul_u32_u24 v5, 1072, v5
    v_lshl_add_u32 v232, v4, 4, v5
    v_add_u32 v4, 64, v1
    v_mul_u32_u24 v5, 52429, v4
    v_lshrrev_b32 v5, 18, v5
    v_mul_u32_u24 v5, 1072, v5
    v_lshl_add_u32 v233, v4, 4, v5
    v_add_u32 v4, 128, v1
    v_mul_u32_u24 v5, 52429, v4
    v_lshrrev_b32 v5, 18, v5
    v_mul_u32_u24 v5, 1072, v5
    v_lshl_add_u32 v234, v4, 4, v5
    v_add_u32 v4, 192, v1
    v_mul_u32_u24 v5, 52429, v4
    v_lshrrev_b32 v5, 18, v5
    v_mul_u32_u24 v5, 1072, v5
    v_lshl_add_u32 v235, v4, 4, v5
    v_add_u32 v4, 256, v1
    v_mul_u32_u24 v5, 52429, v4
    v_lshrrev_b32 v5, 18, v5
    v_mul_u32_u24 v5, 1072, v5
    v_lshl_add_u32 v236, v4, 4, v5
    v_add_u32 v4, 1280, v0
    v_mul_u32_u24 v5, 52429, v4
    v_lshrrev_b32 v5, 18, v5
    v_mul_u32_u24 v5, 1072, v5
    v_lshl_add_u32 v237, v4, 4, v5
    v_lshlrev_b32 v4, 8, v1
    v_lshl_add_u32 v4, v3, 4, v4
    v_add_u32 v227, s94, v4
    s_waitcnt vmcnt(4)
    v_xor_b32 v4, 0, v227
    ds_read_b128 a[0:3], v4
    v_xor_b32 v5, 16, v227
    ds_read_b128 a[4:7], v5
    v_xor_b32 v4, 32, v227
    ds_read_b128 a[8:11], v4
    v_xor_b32 v5, 48, v227
    ds_read_b128 a[12:15], v5
    v_xor_b32 v4, 64, v227
    ds_read_b128 a[16:19], v4
    v_xor_b32 v5, 80, v227
    ds_read_b128 a[20:23], v5
    v_xor_b32 v4, 96, v227
    ds_read_b128 a[24:27], v4
    v_xor_b32 v5, 112, v227
    ds_read_b128 a[28:31], v5
    v_xor_b32 v4, 128, v227
    ds_read_b128 a[32:35], v4
    v_xor_b32 v5, 144, v227
    ds_read_b128 a[36:39], v5
    v_xor_b32 v4, 160, v227
    ds_read_b128 a[40:43], v4
    v_xor_b32 v5, 176, v227
    ds_read_b128 a[44:47], v5
    v_xor_b32 v4, 192, v227
    ds_read_b128 a[48:51], v4
    v_xor_b32 v5, 208, v227
    ds_read_b128 a[52:55], v5
    v_xor_b32 v4, 224, v227
    ds_read_b128 a[56:59], v4
    v_xor_b32 v5, 240, v227
    ds_read_b128 a[60:63], v5
    s_waitcnt lgkmcnt(0)
    s_barrier
    buffer_load_dwordx4 v[144:147], v15, s[64:67], 0 offen sc1
    buffer_load_dwordx4 v[128:131], v14, s[64:67], 0 offen sc1
    buffer_load_dwordx4 v[132:135], v14, s[64:67], 0 offen offset:1024 sc1
    buffer_load_dwordx4 v[136:139], v14, s[64:67], 0 offen offset:2048 sc1
    buffer_load_dwordx4 v[140:143], v14, s[64:67], 0 offen offset:3072 sc1
    s_mul_i32 s95, s76, 5184
    s_mov_b32 exec_hi, 0x3fffff
    s_add_u32 m0, s95, 0
    s_mov_b32 s93, 0
    buffer_load_dwordx4 v230, s[44:47], s93 offen nt lds
    s_add_u32 m0, s95, 20736
    s_mov_b32 s93, 0
    buffer_load_dwordx4 v230, s[48:51], s93 offen nt lds
    s_add_u32 m0, s95, 864
    s_mov_b32 s93, 0
    buffer_load_dwordx4 v231, s[44:47], s93 offen nt lds
    s_add_u32 m0, s95, 21600
    s_mov_b32 s93, 0
    buffer_load_dwordx4 v231, s[48:51], s93 offen nt lds
    s_add_u32 m0, s95, 1728
    s_mov_b32 s93, 27648
    buffer_load_dwordx4 v230, s[44:47], s93 offen nt lds
    s_add_u32 m0, s95, 22464
    s_mov_b32 s93, 27648
    buffer_load_dwordx4 v230, s[48:51], s93 offen nt lds
    s_add_u32 m0, s95, 2592
    s_mov_b32 s93, 27648
    buffer_load_dwordx4 v231, s[44:47], s93 offen nt lds
    s_add_u32 m0, s95, 23328
    s_mov_b32 s93, 27648
    buffer_load_dwordx4 v231, s[48:51], s93 offen nt lds
    s_add_u32 m0, s95, 3456
    s_mov_b32 s93, 55296
    buffer_load_dwordx4 v230, s[44:47], s93 offen nt lds
    s_add_u32 m0, s95, 24192
    s_mov_b32 s93, 55296
    buffer_load_dwordx4 v230, s[48:51], s93 offen nt lds
    s_add_u32 m0, s95, 4320
    s_mov_b32 s93, 55296
    buffer_load_dwordx4 v231, s[44:47], s93 offen nt lds
    s_add_u32 m0, s95, 25056
    s_mov_b32 s93, 55296
    buffer_load_dwordx4 v231, s[48:51], s93 offen nt lds
    s_mov_b32 exec_hi, -1
    s_waitcnt vmcnt(12)
    v_cmp_ne_u32 s[100:101], s80, v147
    v_add_f32_dpp v218, v144, v144 row_ror:8 row_mask:0xf bank_mask:0xf
    v_add_f32_dpp v219, v145, v145 row_ror:8 row_mask:0xf bank_mask:0xf
    s_nop 0
    v_add_f32_dpp v218, v218, v218 row_ror:4 row_mask:0xf bank_mask:0xf
    v_add_f32_dpp v219, v219, v219 row_ror:4 row_mask:0xf bank_mask:0xf
    v_mfma_f32_16x16x32_bf16 v[112:115], v[36:39], v[128:131], 0
    v_bitop3_b32 v4, v128, v130, s80 bitop3:0x7e
    v_bitop3_b32 v5, v129, v131, s81 bitop3:0x7e
    v_or_b32 v220, v4, v5
    v_add_f32_dpp v218, v218, v218 row_ror:2 row_mask:0xf bank_mask:0xf
    v_add_f32_dpp v219, v219, v219 row_ror:2 row_mask:0xf bank_mask:0xf
    s_nop 0
    v_add_f32_dpp v218, v218, v218 row_ror:1 row_mask:0xf bank_mask:0xf
    v_add_f32_dpp v219, v219, v219 row_ror:1 row_mask:0xf bank_mask:0xf
    v_mfma_f32_16x16x32_bf16 v[112:115], v[36:39], v[132:135], v[112:115]
    v_bitop3_b32 v4, v132, v134, s80 bitop3:0x7e
    v_bitop3_b32 v5, v133, v135, s81 bitop3:0x7e
    v_or3_b32 v220, v4, v5, v220
    v_mul_f32 v216, s5, v218
    v_fma_f32 v217, v219, s5, v55
    v_fma_f32 v217, -v216, v216, v217
    v_rsq_f32 v217, v217
    v_mfma_f32_16x16x32_bf16 v[112:115], v[36:39], v[136:139], v[112:115]
    v_bitop3_b32 v4, v136, v138, s80 bitop3:0x7e
    v_bitop3_b32 v5, v137, v139, s81 bitop3:0x7e
    v_or3_b32 v220, v4, v5, v220
    v_mul_f32 v80, v216, v192
    v_mul_f32 v217, s4, v217
    v_mul_f32 v80, v80, v217
    v_mfma_f32_16x16x32_bf16 v[112:115], v[36:39], v[140:143], v[112:115]
    v_bitop3_b32 v4, v140, v142, s80 bitop3:0x7e
    v_bitop3_b32 v5, v141, v143, s81 bitop3:0x7e
    v_or3_b32 v220, v4, v5, v220
    v_cmp_ne_u16 vcc, 0, v220
    s_nop 0
    s_or_b64 vcc, vcc, s[100:101]
    s_branch GA_CHECK
GA_PRE:
    s_waitcnt vmcnt(0)
GA_ISSUE:
    buffer_load_dwordx4 v[144:147], v15, s[64:67], 0 offen sc1
    buffer_load_dwordx4 v[128:131], v14, s[64:67], 0 offen sc1
    buffer_load_dwordx4 v[132:135], v14, s[64:67], 0 offen offset:1024 sc1
    buffer_load_dwordx4 v[136:139], v14, s[64:67], 0 offen offset:2048 sc1
    buffer_load_dwordx4 v[140:143], v14, s[64:67], 0 offen offset:3072 sc1
    s_waitcnt vmcnt(4)
GA_RED:
    v_cmp_ne_u32 s[100:101], s80, v147
    v_add_f32_dpp v218, v144, v144 row_ror:8 row_mask:0xf bank_mask:0xf
    v_add_f32_dpp v219, v145, v145 row_ror:8 row_mask:0xf bank_mask:0xf
    s_nop 0
    v_add_f32_dpp v218, v218, v218 row_ror:4 row_mask:0xf bank_mask:0xf
    v_add_f32_dpp v219, v219, v219 row_ror:4 row_mask:0xf bank_mask:0xf
    s_waitcnt vmcnt(3)
    v_mfma_f32_16x16x32_bf16 v[112:115], v[36:39], v[128:131], 0
    v_bitop3_b32 v4, v128, v130, s80 bitop3:0x7e
    v_bitop3_b32 v5, v129, v131, s81 bitop3:0x7e
    v_or_b32 v220, v4, v5
    v_add_f32_dpp v218, v218, v218 row_ror:2 row_mask:0xf bank_mask:0xf
    v_add_f32_dpp v219, v219, v219 row_ror:2 row_mask:0xf bank_mask:0xf
    s_nop 0
    v_add_f32_dpp v218, v218, v218 row_ror:1 row_mask:0xf bank_mask:0xf
    v_add_f32_dpp v219, v219, v219 row_ror:1 row_mask:0xf bank_mask:0xf
    s_waitcnt vmcnt(2)
    v_mfma_f32_16x16x32_bf16 v[112:115], v[36:39], v[132:135], v[112:115]
    v_bitop3_b32 v4, v132, v134, s80 bitop3:0x7e
    v_bitop3_b32 v5, v133, v135, s81 bitop3:0x7e
    v_or3_b32 v220, v4, v5, v220
    v_mul_f32 v216, s5, v218
    v_fma_f32 v217, v219, s5, v55
    v_fma_f32 v217, -v216, v216, v217
    v_rsq_f32 v217, v217
    s_waitcnt vmcnt(1)
    v_mfma_f32_16x16x32_bf16 v[112:115], v[36:39], v[136:139], v[112:115]
    v_bitop3_b32 v4, v136, v138, s80 bitop3:0x7e
    v_bitop3_b32 v5, v137, v139, s81 bitop3:0x7e
    v_or3_b32 v220, v4, v5, v220
    v_mul_f32 v80, v216, v192
    v_mul_f32 v217, s4, v217
    v_mul_f32 v80, v80, v217
    s_waitcnt vmcnt(0)
    v_mfma_f32_16x16x32_bf16 v[112:115], v[36:39], v[140:143], v[112:115]
    v_bitop3_b32 v4, v140, v142, s80 bitop3:0x7e
    v_bitop3_b32 v5, v141, v143, s81 bitop3:0x7e
    v_or3_b32 v220, v4, v5, v220
    v_cmp_ne_u16 vcc, 0, v220
    s_nop 0
    s_or_b64 vcc, vcc, s[100:101]
GA_CHECK:
    s_cbranch_scc1 RETRY_A
CONT_A:
    s_nop 0
    v_fma_f32 v4, v112, v217, -v80
    v_cvt_pk_bf16_f32 v5, v4, v4
    ds_write_b16 v19, v5
    s_waitcnt lgkmcnt(0)
    s_barrier
    ds_read_b64 v[102:103], v20
    ds_read_b64 v[104:105], v20 offset:128
    v_add_f32 v56, v56, v216
    v_sub_f32 v188, v184, v56
    v_sub_f32 v189, v185, v56
    v_sub_f32 v190, v186, v56
    v_sub_f32 v191, v187, v56
    s_cmp_eq_u32 s83, 0
    s_cbranch_scc1 L1_MODE
BACK_MODE:
    s_waitcnt lgkmcnt(0)
    v_mfma_f32_4x4x4_16b_bf16 v[112:115], v[102:103], a[0:1], 0 cbsz:4 abid:0
    v_mfma_f32_4x4x4_16b_bf16 v[116:119], v[102:103], a[2:3], 0 cbsz:4 abid:1
    v_mfma_f32_4x4x4_16b_bf16 v[120:123], v[102:103], a[4:5], 0 cbsz:4 abid:2
    v_mfma_f32_4x4x4_16b_bf16 v[112:115], v[102:103], a[6:7], v[112:115] cbsz:4 abid:3
    v_mfma_f32_4x4x4_16b_bf16 v[116:119], v[102:103], a[8:9], v[116:119] cbsz:4 abid:4
    v_mfma_f32_4x4x4_16b_bf16 v[120:123], v[102:103], a[10:11], v[120:123] cbsz:4 abid:5
    v_mfma_f32_4x4x4_16b_bf16 v[112:115], v[102:103], a[12:13], v[112:115] cbsz:4 abid:6
    v_mfma_f32_4x4x4_16b_bf16 v[116:119], v[102:103], a[14:15], v[116:119] cbsz:4 abid:7
    v_mfma_f32_4x4x4_16b_bf16 v[120:123], v[102:103], a[16:17], v[120:123] cbsz:4 abid:8
    v_mfma_f32_4x4x4_16b_bf16 v[112:115], v[102:103], a[18:19], v[112:115] cbsz:4 abid:9
    v_mfma_f32_4x4x4_16b_bf16 v[116:119], v[102:103], a[20:21], v[116:119] cbsz:4 abid:10
    v_mfma_f32_4x4x4_16b_bf16 v[120:123], v[102:103], a[22:23], v[120:123] cbsz:4 abid:11
    v_mfma_f32_4x4x4_16b_bf16 v[112:115], v[102:103], a[24:25], v[112:115] cbsz:4 abid:12
    v_mfma_f32_4x4x4_16b_bf16 v[116:119], v[102:103], a[26:27], v[116:119] cbsz:4 abid:13
    v_mfma_f32_4x4x4_16b_bf16 v[120:123], v[102:103], a[28:29], v[120:123] cbsz:4 abid:14
    v_mfma_f32_4x4x4_16b_bf16 v[112:115], v[102:103], a[30:31], v[112:115] cbsz:4 abid:15
    v_mfma_f32_4x4x4_16b_bf16 v[116:119], v[104:105], a[32:33], v[116:119] cbsz:4 abid:0
    v_mfma_f32_4x4x4_16b_bf16 v[120:123], v[104:105], a[34:35], v[120:123] cbsz:4 abid:1
    v_mfma_f32_4x4x4_16b_bf16 v[112:115], v[104:105], a[36:37], v[112:115] cbsz:4 abid:2
    v_mfma_f32_4x4x4_16b_bf16 v[116:119], v[104:105], a[38:39], v[116:119] cbsz:4 abid:3
    v_mfma_f32_4x4x4_16b_bf16 v[120:123], v[104:105], a[40:41], v[120:123] cbsz:4 abid:4
    v_mfma_f32_4x4x4_16b_bf16 v[112:115], v[104:105], a[42:43], v[112:115] cbsz:4 abid:5
    v_mfma_f32_4x4x4_16b_bf16 v[116:119], v[104:105], a[44:45], v[116:119] cbsz:4 abid:6
    v_mfma_f32_4x4x4_16b_bf16 v[120:123], v[104:105], a[46:47], v[120:123] cbsz:4 abid:7
    v_mfma_f32_4x4x4_16b_bf16 v[112:115], v[104:105], a[48:49], v[112:115] cbsz:4 abid:8
    v_mfma_f32_4x4x4_16b_bf16 v[116:119], v[104:105], a[50:51], v[116:119] cbsz:4 abid:9
    v_mfma_f32_4x4x4_16b_bf16 v[120:123], v[104:105], a[52:53], v[120:123] cbsz:4 abid:10
    v_mfma_f32_4x4x4_16b_bf16 v[112:115], v[104:105], a[54:55], v[112:115] cbsz:4 abid:11
    v_mfma_f32_4x4x4_16b_bf16 v[116:119], v[104:105], a[56:57], v[116:119] cbsz:4 abid:12
    v_mfma_f32_4x4x4_16b_bf16 v[120:123], v[104:105], a[58:59], v[120:123] cbsz:4 abid:13
    v_mfma_f32_4x4x4_16b_bf16 v[112:115], v[104:105], a[60:61], v[112:115] cbsz:4 abid:14
    v_mfma_f32_4x4x4_16b_bf16 v[116:119], v[104:105], a[62:63], v[116:119] cbsz:4 abid:15
    s_nop 3
    v_pk_add_f32 v[198:199], v[120:121], v[112:113]
    v_pk_add_f32 v[198:199], v[198:199], v[116:117]
    s_nop 1
    v_max_f32_dpp v72, v198, v198 row_ror:8 row_mask:0xf bank_mask:0xf
    v_max_f32_dpp v74, v199, v199 row_ror:8 row_mask:0xf bank_mask:0xf
    s_nop 0
    v_max_f32_dpp v72, v72, v72 row_ror:4 row_mask:0xf bank_mask:0xf
    v_max_f32_dpp v74, v74, v74 row_ror:4 row_mask:0xf bank_mask:0xf
    s_nop 0
    v_max_f32_dpp v72, v72, v72 row_ror:2 row_mask:0xf bank_mask:0xf
    v_max_f32_dpp v74, v74, v74 row_ror:2 row_mask:0xf bank_mask:0xf
    s_nop 0
    v_max_f32_dpp v72, v72, v72 row_ror:1 row_mask:0xf bank_mask:0xf
    v_max_f32_dpp v74, v74, v74 row_ror:1 row_mask:0xf bank_mask:0xf
    s_nop 0
    v_max_f32_dpp v72, v72, v72 row_bcast:15 row_mask:0xa bank_mask:0xf
    v_max_f32_dpp v74, v74, v74 row_bcast:15 row_mask:0xa bank_mask:0xf
    s_nop 0
    v_max_f32_dpp v72, v72, v72 row_bcast:31 row_mask:0xc bank_mask:0xf
    v_max_f32_dpp v74, v74, v74 row_bcast:31 row_mask:0xc bank_mask:0xf
    v_ceil_f32 v72, v72
    v_ceil_f32 v74, v74
    v_readlane_b32 s91, v72, 63
    v_readlane_b32 s92, v74, 63
    s_nop 0
    v_subrev_f32 v198, s91, v198
    v_subrev_f32 v199, s92, v199
    v_exp_f32 v198, v198
    v_exp_f32 v199, v199
    s_nop 0
    v_cvt_pk_bf16_f32 v4, v198, v199
    s_nop 1
    v_mov_b32_dpp v5, v4 quad_perm:[1,0,3,2] row_mask:0xf bank_mask:0xf
    v_perm_b32 v106, v5, v4, v52
    s_nop 1
    v_mov_b32_dpp v107, v106 quad_perm:[2,3,2,3] row_mask:0xf bank_mask:0xf
    s_cmp_eq_u32 s83, 0
    s_cbranch_scc1 L1_PV
BACK_PV:
    v_mfma_f32_4x4x4_16b_bf16 v[112:115], v[106:107], a[64:65], 0 cbsz:4 abid:0
    v_add_f32_dpp v73, v198, v198 row_ror:8 row_mask:0xf bank_mask:0xf
    v_mfma_f32_4x4x4_16b_bf16 v[116:119], v[106:107], a[66:67], 0 cbsz:4 abid:0
    v_add_f32_dpp v75, v199, v199 row_ror:8 row_mask:0xf bank_mask:0xf
    v_mfma_f32_4x4x4_16b_bf16 v[120:123], v[106:107], a[68:69], 0 cbsz:4 abid:1
    v_add_f32_dpp v73, v73, v73 row_ror:4 row_mask:0xf bank_mask:0xf
    v_mfma_f32_4x4x4_16b_bf16 v[124:127], v[106:107], a[70:71], 0 cbsz:4 abid:1
    v_add_f32_dpp v75, v75, v75 row_ror:4 row_mask:0xf bank_mask:0xf
    v_mfma_f32_4x4x4_16b_bf16 v[112:115], v[106:107], a[72:73], v[112:115] cbsz:4 abid:2
    v_add_f32_dpp v73, v73, v73 row_ror:2 row_mask:0xf bank_mask:0xf
    v_mfma_f32_4x4x4_16b_bf16 v[116:119], v[106:107], a[74:75], v[116:119] cbsz:4 abid:2
    v_add_f32_dpp v75, v75, v75 row_ror:2 row_mask:0xf bank_mask:0xf
    v_mfma_f32_4x4x4_16b_bf16 v[120:123], v[106:107], a[76:77], v[120:123] cbsz:4 abid:3
    v_add_f32_dpp v73, v73, v73 row_ror:1 row_mask:0xf bank_mask:0xf
    v_mfma_f32_4x4x4_16b_bf16 v[124:127], v[106:107], a[78:79], v[124:127] cbsz:4 abid:3
    v_add_f32_dpp v75, v75, v75 row_ror:1 row_mask:0xf bank_mask:0xf
    v_mfma_f32_4x4x4_16b_bf16 v[112:115], v[106:107], a[80:81], v[112:115] cbsz:4 abid:4
    v_add_f32_dpp v73, v73, v73 row_bcast:15 row_mask:0xa bank_mask:0xf
    v_mfma_f32_4x4x4_16b_bf16 v[116:119], v[106:107], a[82:83], v[116:119] cbsz:4 abid:4
    v_add_f32_dpp v75, v75, v75 row_bcast:15 row_mask:0xa bank_mask:0xf
    v_mfma_f32_4x4x4_16b_bf16 v[120:123], v[106:107], a[84:85], v[120:123] cbsz:4 abid:5
    v_add_f32_dpp v73, v73, v73 row_bcast:31 row_mask:0xc bank_mask:0xf
    v_mfma_f32_4x4x4_16b_bf16 v[124:127], v[106:107], a[86:87], v[124:127] cbsz:4 abid:5
    v_add_f32_dpp v75, v75, v75 row_bcast:31 row_mask:0xc bank_mask:0xf
    v_mfma_f32_4x4x4_16b_bf16 v[112:115], v[106:107], a[88:89], v[112:115] cbsz:4 abid:6
    ds_write2_b32 v23, v72, v73 offset0:0 offset1:4
    v_mfma_f32_4x4x4_16b_bf16 v[116:119], v[106:107], a[90:91], v[116:119] cbsz:4 abid:6
    ds_write2_b32 v23, v74, v75 offset0:8 offset1:12
    v_mfma_f32_4x4x4_16b_bf16 v[120:123], v[106:107], a[92:93], v[120:123] cbsz:4 abid:7
    v_mfma_f32_4x4x4_16b_bf16 v[124:127], v[106:107], a[94:95], v[124:127] cbsz:4 abid:7
    v_mfma_f32_4x4x4_16b_bf16 v[112:115], v[106:107], a[96:97], v[112:115] cbsz:4 abid:8
    v_mfma_f32_4x4x4_16b_bf16 v[116:119], v[106:107], a[98:99], v[116:119] cbsz:4 abid:8
    v_mfma_f32_4x4x4_16b_bf16 v[120:123], v[106:107], a[100:101], v[120:123] cbsz:4 abid:9
    v_mfma_f32_4x4x4_16b_bf16 v[124:127], v[106:107], a[102:103], v[124:127] cbsz:4 abid:9
    v_mfma_f32_4x4x4_16b_bf16 v[112:115], v[106:107], a[104:105], v[112:115] cbsz:4 abid:10
    v_mfma_f32_4x4x4_16b_bf16 v[116:119], v[106:107], a[106:107], v[116:119] cbsz:4 abid:10
    v_mfma_f32_4x4x4_16b_bf16 v[120:123], v[106:107], a[108:109], v[120:123] cbsz:4 abid:11
    v_mfma_f32_4x4x4_16b_bf16 v[124:127], v[106:107], a[110:111], v[124:127] cbsz:4 abid:11
    s_cmp_eq_u32 s83, 0
    s_cbranch_scc1 L1_PV2
BACK_PV2:
    v_mfma_f32_4x4x4_16b_bf16 v[112:115], v[106:107], a[112:113], v[112:115] cbsz:4 abid:12
    v_mfma_f32_4x4x4_16b_bf16 v[116:119], v[106:107], a[114:115], v[116:119] cbsz:4 abid:12
    v_mfma_f32_4x4x4_16b_bf16 v[120:123], v[106:107], a[116:117], v[120:123] cbsz:4 abid:13
    v_mfma_f32_4x4x4_16b_bf16 v[124:127], v[106:107], a[118:119], v[124:127] cbsz:4 abid:13
    v_mfma_f32_4x4x4_16b_bf16 v[112:115], v[106:107], a[120:121], v[112:115] cbsz:4 abid:14
    v_mfma_f32_4x4x4_16b_bf16 v[116:119], v[106:107], a[122:123], v[116:119] cbsz:4 abid:14
    v_mfma_f32_4x4x4_16b_bf16 v[120:123], v[106:107], a[124:125], v[120:123] cbsz:4 abid:15
    v_mfma_f32_4x4x4_16b_bf16 v[124:127], v[106:107], a[126:127], v[124:127] cbsz:4 abid:15
    s_nop 3
    v_pk_add_f32 v[202:203], v[112:113], v[120:121]
    v_pk_add_f32 v[204:205], v[116:117], v[124:125]
    ds_write2st64_b32 v21, v202, v203 offset0:0 offset1:8
    ds_write2st64_b32 v21, v204, v205 offset0:4 offset1:12
PV_DONE:
    s_waitcnt lgkmcnt(0)
    s_barrier
    ds_read_b128 v[208:211], v24
    ds_read2st64_b32 v[202:203], v22 offset0:0 offset1:1
    ds_read2st64_b32 v[204:205], v22 offset0:2 offset1:3
    ds_read_b128 v[212:215], v24 offset:16
    s_waitcnt lgkmcnt(3)
    v_max3_f32 v68, v208, v209, v210
    v_max_f32 v68, v68, v211
    v_sub_f32 v208, v208, v68
    v_sub_f32 v209, v209, v68
    v_sub_f32 v210, v210, v68
    v_sub_f32 v211, v211, v68
    v_exp_f32 v208, v208
    v_exp_f32 v209, v209
    v_exp_f32 v210, v210
    v_exp_f32 v211, v211
    s_waitcnt lgkmcnt(0)
    v_mul_f32 v4, v208, v202
    v_fmac_f32 v4, v209, v203
    v_fmac_f32 v4, v210, v204
    v_fmac_f32 v4, v211, v205
    v_cvt_pk_bf16_f32 v6, v53, v4
    buffer_store_dword v6, v13, s[68:71], s87 offen
    v_mul_f32 v69, v208, v212
    v_fmac_f32 v69, v209, v213
    v_fmac_f32 v69, v210, v214
    v_fmac_f32 v69, v211, v215
    buffer_store_dwordx4 v[68:71], v18, s[68:71], 0 offen
    buffer_store_dword v6, v13, s[72:75], s87 offen sc1
    buffer_store_dwordx4 v[68:71], v18, s[72:75], 0 offen sc1
    s_cmp_lg_u32 s83, 0
    s_cbranch_scc1 GB_PRE
    v_lshrrev_b32 v4, 2, v3
    v_lshl_add_u32 v4, v2, 3, v4
    v_mul_u32_u24 v4, 80, v4
    v_and_b32 v5, 3, v1
    v_lshl_add_u32 v4, v5, 3, v4
    s_and_b32 s93, s78, 1
    s_lshl_b32 s93, s93, 3
    s_mul_i32 s96, s76, 24
    s_add_u32 s93, s93, s96
    s_add_u32 s93, s93, 138240
    v_add_u32 v227, s93, v4
    s_waitcnt vmcnt(4)
    s_barrier
    ds_read_b64_tr_b16 a[184:185], v227 offset:0
    ds_read_b64_tr_b16 a[186:187], v227 offset:320
    ds_read_b64_tr_b16 a[188:189], v227 offset:2560
    ds_read_b64_tr_b16 a[190:191], v227 offset:2880
    ds_read_b64_tr_b16 a[192:193], v227 offset:5120
    ds_read_b64_tr_b16 a[194:195], v227 offset:5440
    ds_read_b64_tr_b16 a[196:197], v227 offset:7680
    ds_read_b64_tr_b16 a[198:199], v227 offset:8000
    ds_read_b64_tr_b16 a[200:201], v227 offset:10240
    ds_read_b64_tr_b16 a[202:203], v227 offset:10560
    ds_read_b64_tr_b16 a[204:205], v227 offset:12800
    ds_read_b64_tr_b16 a[206:207], v227 offset:13120
    ds_read_b64_tr_b16 a[208:209], v227 offset:15360
    ds_read_b64_tr_b16 a[210:211], v227 offset:15680
    ds_read_b64_tr_b16 a[212:213], v227 offset:17920
    ds_read_b64_tr_b16 a[214:215], v227 offset:18240
GB_PRE:
    s_waitcnt vmcnt(0)
GB_ISSUE:
    buffer_load_dwordx4 v[144:147], v17, s[64:67], 0 offen sc1
    buffer_load_dwordx4 v[128:131], v14, s[64:67], s87 offen sc1
    buffer_load_dwordx4 v[132:135], v14, s[64:67], s87 offen offset:1024 sc1
    buffer_load_dwordx4 v[136:139], v14, s[64:67], s87 offen offset:2048 sc1
    buffer_load_dwordx4 v[140:143], v14, s[64:67], s87 offen offset:3072 sc1
    s_waitcnt vmcnt(4)
GB_RED:
    v_cmp_ne_u32 s[100:101], s80, v147
    v_max_f32_dpp v218, v144, v144 row_ror:8 row_mask:0xf bank_mask:0xf
    s_nop 1
    v_max_f32_dpp v218, v218, v218 row_ror:4 row_mask:0xf bank_mask:0xf
    s_nop 1
    v_max_f32_dpp v218, v218, v218 row_ror:2 row_mask:0xf bank_mask:0xf
    s_nop 1
    v_max_f32_dpp v218, v218, v218 row_ror:1 row_mask:0xf bank_mask:0xf
    v_sub_f32 v218, v144, v218
    v_exp_f32 v218, v218
    s_nop 0
    v_mul_f32 v219, v218, v145
    v_and_b32_dpp v156, v218, v40 row_newbcast:0 row_mask:0xf bank_mask:0xf
    v_and_b32_dpp v157, v218, v41 row_newbcast:0 row_mask:0xf bank_mask:0xf
    v_and_b32_dpp v158, v218, v42 row_newbcast:0 row_mask:0xf bank_mask:0xf
    v_and_b32_dpp v159, v218, v43 row_newbcast:0 row_mask:0xf bank_mask:0xf
    v_add_f32_dpp v219, v219, v219 row_ror:8 row_mask:0xf bank_mask:0xf
    s_waitcnt vmcnt(3)
    v_mfma_f32_16x16x32_bf16 v[112:115], v[156:159], v[128:131], 0
    v_bitop3_b32 v4, v128, v130, s80 bitop3:0x7e
    v_bitop3_b32 v5, v129, v131, s81 bitop3:0x7e
    v_or_b32 v220, v4, v5
    v_and_b32_dpp v160, v218, v40 row_newbcast:1 row_mask:0xf bank_mask:0xf
    v_and_b32_dpp v161, v218, v41 row_newbcast:1 row_mask:0xf bank_mask:0xf
    v_and_b32_dpp v162, v218, v42 row_newbcast:1 row_mask:0xf bank_mask:0xf
    v_and_b32_dpp v163, v218, v43 row_newbcast:1 row_mask:0xf bank_mask:0xf
    v_add_f32_dpp v219, v219, v219 row_ror:4 row_mask:0xf bank_mask:0xf
    s_waitcnt vmcnt(2)
    v_mfma_f32_16x16x32_bf16 v[112:115], v[160:163], v[132:135], v[112:115]
    v_bitop3_b32 v4, v132, v134, s80 bitop3:0x7e
    v_bitop3_b32 v5, v133, v135, s81 bitop3:0x7e
    v_or3_b32 v220, v4, v5, v220
    v_and_b32_dpp v164, v218, v40 row_newbcast:2 row_mask:0xf bank_mask:0xf
    v_and_b32_dpp v165, v218, v41 row_newbcast:2 row_mask:0xf bank_mask:0xf
    v_and_b32_dpp v166, v218, v42 row_newbcast:2 row_mask:0xf bank_mask:0xf
    v_and_b32_dpp v167, v218, v43 row_newbcast:2 row_mask:0xf bank_mask:0xf
    v_add_f32_dpp v219, v219, v219 row_ror:2 row_mask:0xf bank_mask:0xf
    s_waitcnt vmcnt(1)
    v_mfma_f32_16x16x32_bf16 v[112:115], v[164:167], v[136:139], v[112:115]
    v_bitop3_b32 v4, v136, v138, s80 bitop3:0x7e
    v_bitop3_b32 v5, v137, v139, s81 bitop3:0x7e
    v_or3_b32 v220, v4, v5, v220
    v_and_b32_dpp v168, v218, v40 row_newbcast:3 row_mask:0xf bank_mask:0xf
    v_and_b32_dpp v169, v218, v41 row_newbcast:3 row_mask:0xf bank_mask:0xf
    v_and_b32_dpp v170, v218, v42 row_newbcast:3 row_mask:0xf bank_mask:0xf
    v_and_b32_dpp v171, v218, v43 row_newbcast:3 row_mask:0xf bank_mask:0xf
    v_add_f32_dpp v219, v219, v219 row_ror:1 row_mask:0xf bank_mask:0xf
    s_waitcnt vmcnt(0)
    v_mfma_f32_16x16x32_bf16 v[112:115], v[168:171], v[140:143], v[112:115]
    v_bitop3_b32 v4, v140, v142, s80 bitop3:0x7e
    v_bitop3_b32 v5, v141, v143, s81 bitop3:0x7e
    v_or3_b32 v220, v4, v5, v220
    v_cmp_ne_u16 vcc, 0, v220
    v_rcp_f32 v219, v219
    s_or_b64 vcc, vcc, s[100:101]
GB_CHECK:
    s_cbranch_scc1 RETRY_B
CONT_B:
    s_nop 0
    v_mul_f32 v4, v112, v219
    v_cvt_pk_bf16_f32 v5, v4, v4
    ds_write_b16 v78, v5
    v_mov_b32 v116, 0
    v_mov_b32 v117, 0
    s_cmp_eq_u32 s76, 3
    s_cbranch_scc1 W3_C
    s_waitcnt lgkmcnt(0)
    s_barrier
    ds_read_b128 v[156:159], v25 offset:0
    ds_read_b128 v[160:163], v25 offset:128
    ds_read_b128 v[164:167], v25 offset:256
    ds_read_b128 v[168:171], v25 offset:384
    s_waitcnt lgkmcnt(3)
    v_smfmac_f32_16x16x64_bf16 v[116:119], v[156:159], a[184:191], v77
    s_waitcnt lgkmcnt(2)
    v_smfmac_f32_16x16x64_bf16 v[116:119], v[160:163], a[192:199], v77
    s_waitcnt lgkmcnt(1)
    v_smfmac_f32_16x16x64_bf16 v[116:119], v[164:167], a[200:207], v77
    s_waitcnt lgkmcnt(0)
    v_smfmac_f32_16x16x64_bf16 v[116:119], v[168:171], a[208:215], v77
    s_nop 7
    v_add_f32 v4, v116, v117
    v_cvt_pk_bf16_f32 v5, v76, v4
    buffer_store_dword v5, v26, s[64:67], s90 offen sc1
    s_cmp_lg_u32 s83, 0
    s_cbranch_scc1 C_WAIT
    s_barrier
    buffer_load_dwordx4 v[156:159], v30, s[64:67], s89 offen sc1
    buffer_load_dwordx4 v[160:163], v30, s[64:67], s89 offen offset:1536 sc1
    buffer_load_dwordx4 v[164:167], v31, s[64:67], s89 offen sc1
    buffer_load_dwordx4 v[168:171], v31, s[64:67], s89 offen offset:1536 sc1
    buffer_load_dwordx4 v[172:175], v32, s[64:67], s89 offen sc1
    buffer_load_dwordx4 v[176:179], v32, s[64:67], s89 offen offset:1536 sc1
    s_waitcnt vmcnt(0)
CHECK_CG:
    v_mfma_f32_16x16x32_bf16 v[120:123], v[48:51], v[156:159], 0
    v_mfma_f32_16x16x32_bf16 v[120:123], v[48:51], v[160:163], v[120:123]
    v_mfma_f32_16x16x32_bf16 v[120:123], v[48:51], v[164:167], v[120:123]
    v_mfma_f32_16x16x32_bf16 v[120:123], v[48:51], v[168:171], v[120:123]
    v_mfma_f32_16x16x32_bf16 v[124:127], v[48:51], v[172:175], 0
    v_mfma_f32_16x16x32_bf16 v[124:127], v[48:51], v[176:179], v[124:127]
    v_bitop3_b32 v4, v157, v161, s82 bitop3:0x7e
    v_bitop3_b32 v5, v159, v163, s80 bitop3:0x7e
    v_or_b32 v220, v4, v5
    v_bitop3_b32 v4, v165, v169, s82 bitop3:0x7e
    v_bitop3_b32 v5, v167, v171, s80 bitop3:0x7e
    v_or3_b32 v220, v4, v5, v220
    v_bitop3_b32 v4, v173, v177, s82 bitop3:0x7e
    v_bitop3_b32 v5, v175, v179, s80 bitop3:0x7e
    v_or3_b32 v220, v4, v5, v220
    v_cmp_lt_u32 vcc, 0xffff, v220
    s_nop 0
    s_cmp_lg_u64 vcc, 0
    s_cbranch_scc1 RETRY_CG
CONT_CG:
    v_mov_b32 v194, v120
    v_mov_b32 v195, v121
    v_add_f32_dpp v196, v124, v124 row_ror:8 row_mask:0xf bank_mask:0xf
    v_add_f32_dpp v197, v125, v125 row_ror:8 row_mask:0xf bank_mask:0xf
    s_branch C_BAR
C_WAIT:
    s_waitcnt vmcnt(0)
    s_barrier
C_BAR:
    s_barrier
    ds_read_b64 v[100:101], v12
    s_add_u32 s90, s90, 0x20000
    s_waitcnt lgkmcnt(0)
    v_mfma_f32_4x4x4_16b_bf16 v[112:115], v[100:101], a[128:129], 0 cbsz:4 abid:0
    v_mfma_f32_4x4x4_16b_bf16 v[116:119], v[100:101], a[146:147], 0 cbsz:4 abid:0
    v_mfma_f32_4x4x4_16b_bf16 v[120:123], v[100:101], a[164:165], 0 cbsz:4 abid:0
    v_mfma_f32_4x4x4_16b_bf16 v[112:115], v[100:101], a[130:131], v[112:115] cbsz:4 abid:1
    v_mfma_f32_4x4x4_16b_bf16 v[116:119], v[100:101], a[148:149], v[116:119] cbsz:4 abid:1
    v_mfma_f32_4x4x4_16b_bf16 v[120:123], v[100:101], a[166:167], v[120:123] cbsz:4 abid:1
    v_mfma_f32_4x4x4_16b_bf16 v[112:115], v[100:101], a[132:133], v[112:115] cbsz:4 abid:2
    v_mfma_f32_4x4x4_16b_bf16 v[116:119], v[100:101], a[150:151], v[116:119] cbsz:4 abid:2
    v_mfma_f32_4x4x4_16b_bf16 v[120:123], v[100:101], a[168:169], v[120:123] cbsz:4 abid:2
    v_mfma_f32_4x4x4_16b_bf16 v[112:115], v[100:101], a[134:135], v[112:115] cbsz:4 abid:3
    v_mfma_f32_4x4x4_16b_bf16 v[116:119], v[100:101], a[152:153], v[116:119] cbsz:4 abid:3
    v_mfma_f32_4x4x4_16b_bf16 v[120:123], v[100:101], a[170:171], v[120:123] cbsz:4 abid:3
    v_mfma_f32_4x4x4_16b_bf16 v[112:115], v[100:101], a[136:137], v[112:115] cbsz:4 abid:4
    v_mfma_f32_4x4x4_16b_bf16 v[116:119], v[100:101], a[154:155], v[116:119] cbsz:4 abid:4
    v_mfma_f32_4x4x4_16b_bf16 v[120:123], v[100:101], a[172:173], v[120:123] cbsz:4 abid:4
    v_mfma_f32_4x4x4_16b_bf16 v[112:115], v[100:101], a[138:139], v[112:115] cbsz:4 abid:5
    v_mfma_f32_4x4x4_16b_bf16 v[116:119], v[100:101], a[156:157], v[116:119] cbsz:4 abid:5
    v_mfma_f32_4x4x4_16b_bf16 v[120:123], v[100:101], a[174:175], v[120:123] cbsz:4 abid:5
    v_mfma_f32_4x4x4_16b_bf16 v[112:115], v[100:101], a[140:141], v[112:115] cbsz:4 abid:6
    v_mfma_f32_4x4x4_16b_bf16 v[116:119], v[100:101], a[158:159], v[116:119] cbsz:4 abid:6
    v_mfma_f32_4x4x4_16b_bf16 v[120:123], v[100:101], a[176:177], v[120:123] cbsz:4 abid:6
    v_mfma_f32_4x4x4_16b_bf16 v[112:115], v[100:101], a[142:143], v[112:115] cbsz:4 abid:7
    v_mfma_f32_4x4x4_16b_bf16 v[116:119], v[100:101], a[160:161], v[116:119] cbsz:4 abid:7
    v_mfma_f32_4x4x4_16b_bf16 v[120:123], v[100:101], a[178:179], v[120:123] cbsz:4 abid:7
    v_mfma_f32_4x4x4_16b_bf16 v[112:115], v[100:101], a[144:145], v[112:115] cbsz:4 abid:8
    v_mfma_f32_4x4x4_16b_bf16 v[116:119], v[100:101], a[162:163], v[116:119] cbsz:4 abid:8
    v_mfma_f32_4x4x4_16b_bf16 v[120:123], v[100:101], a[180:181], v[120:123] cbsz:4 abid:8
    s_nop 3
    v_cvt_pk_bf16_f32 v200, v112, v116
    v_cvt_pk_bf16_f32 v201, v120, v54
    buffer_store_dwordx2 v[200:201], v29, s[68:71], 0 offen
    buffer_store_dwordx2 v[200:201], v29, s[72:75], 0 offen sc1
    s_cmp_lg_u32 s83, 0
    s_cbranch_scc1 GD_ACK
GD_L1:
    v_lshrrev_b32 v4, 2, v3
    v_lshl_add_u32 v4, v2, 3, v4
    v_mul_u32_u24 v4, 80, v4
    v_and_b32 v5, 3, v1
    v_lshl_add_u32 v4, v5, 3, v4
    s_and_b32 s93, s78, 1
    s_lshl_b32 s93, s93, 3
    s_mul_i32 s96, s76, 24
    s_add_u32 s93, s93, s96
    s_add_u32 s93, s93, 65536
    v_add_u32 v227, s93, v4
    s_waitcnt vmcnt(0)
    s_barrier
    ds_read_b64_tr_b16 a[216:217], v227 offset:0
    ds_read_b64_tr_b16 a[218:219], v227 offset:320
    ds_read_b64_tr_b16 a[220:221], v227 offset:2560
    ds_read_b64_tr_b16 a[222:223], v227 offset:2880
    ds_read_b64_tr_b16 a[224:225], v227 offset:5120
    ds_read_b64_tr_b16 a[226:227], v227 offset:5440
    ds_read_b64_tr_b16 a[228:229], v227 offset:7680
    ds_read_b64_tr_b16 a[230:231], v227 offset:8000
    ds_read_b64_tr_b16 a[232:233], v227 offset:10240
    ds_read_b64_tr_b16 a[234:235], v227 offset:10560
    ds_read_b64_tr_b16 a[236:237], v227 offset:12800
    ds_read_b64_tr_b16 a[238:239], v227 offset:13120
    ds_read_b64_tr_b16 a[240:241], v227 offset:15360
    ds_read_b64_tr_b16 a[242:243], v227 offset:15680
    ds_read_b64_tr_b16 a[244:245], v227 offset:17920
    ds_read_b64_tr_b16 a[246:247], v227 offset:18240
    ds_read_b64_tr_b16 a[248:249], v227 offset:20480
    ds_read_b64_tr_b16 a[250:251], v227 offset:20800
GD_ACK:
    s_cmp_eq_u32 s83, 0
    s_cbranch_scc1 GD_ISSUE
    s_waitcnt vmcnt(0)
    s_barrier
GD_ISSUE:
    buffer_load_dwordx4 v[152:155], v15, s[64:67], s88 offen sc1
    buffer_load_dwordx4 v[144:147], v32, s[64:67], 0 offen sc1
    buffer_load_dwordx4 v[148:151], v32, s[64:67], 0 offen offset:1536 sc1
    buffer_load_dwordx4 v[128:131], v30, s[64:67], 0 offen sc1
    buffer_load_dwordx4 v[132:135], v30, s[64:67], 0 offen offset:1536 sc1
    buffer_load_dwordx4 v[136:139], v31, s[64:67], 0 offen sc1
    buffer_load_dwordx4 v[140:143], v31, s[64:67], 0 offen offset:1536 sc1
GD_WAIT:
    s_waitcnt vmcnt(6)
    v_cmp_ne_u32 s[100:101], s80, v155
    v_add_f32_dpp v218, v152, v152 row_ror:8 row_mask:0xf bank_mask:0xf
    v_add_f32_dpp v219, v153, v153 row_ror:8 row_mask:0xf bank_mask:0xf
    s_waitcnt vmcnt(5)
    v_mfma_f32_16x16x32_bf16 v[116:119], v[48:51], v[144:147], 0
    v_add_f32_dpp v218, v218, v218 row_ror:4 row_mask:0xf bank_mask:0xf
    v_add_f32_dpp v219, v219, v219 row_ror:4 row_mask:0xf bank_mask:0xf
    s_waitcnt vmcnt(4)
    v_mfma_f32_16x16x32_bf16 v[116:119], v[48:51], v[148:151], v[116:119]
    v_bitop3_b32 v4, v145, v149, s82 bitop3:0x7e
    v_bitop3_b32 v5, v147, v151, s80 bitop3:0x7e
    v_or_b32 v220, v4, v5
    v_add_f32_dpp v218, v218, v218 row_ror:2 row_mask:0xf bank_mask:0xf
    v_add_f32_dpp v219, v219, v219 row_ror:2 row_mask:0xf bank_mask:0xf
    s_waitcnt vmcnt(3)
    v_mfma_f32_16x16x32_bf16 v[112:115], v[48:51], v[128:131], 0
    v_add_f32_dpp v218, v218, v218 row_ror:1 row_mask:0xf bank_mask:0xf
    v_add_f32_dpp v219, v219, v219 row_ror:1 row_mask:0xf bank_mask:0xf
    s_waitcnt vmcnt(2)
    v_mfma_f32_16x16x32_bf16 v[112:115], v[48:51], v[132:135], v[112:115]
    v_bitop3_b32 v4, v129, v133, s82 bitop3:0x7e
    v_bitop3_b32 v5, v131, v135, s80 bitop3:0x7e
    v_or3_b32 v220, v4, v5, v220
    v_mul_f32 v216, s5, v218
    v_fma_f32 v217, v219, s5, v55
    v_fma_f32 v217, -v216, v216, v217
    v_rsq_f32 v217, v217
    s_waitcnt vmcnt(1)
    v_mfma_f32_16x16x32_bf16 v[112:115], v[48:51], v[136:139], v[112:115]
    v_add_f32_dpp v8, v116, v116 row_ror:8 row_mask:0xf bank_mask:0xf
    v_add_f32_dpp v9, v117, v117 row_ror:8 row_mask:0xf bank_mask:0xf
    v_mul_f32 v217, v217, v217
    s_waitcnt vmcnt(0)
    v_mfma_f32_16x16x32_bf16 v[112:115], v[48:51], v[140:143], v[112:115]
    v_bitop3_b32 v4, v137, v141, s82 bitop3:0x7e
    v_bitop3_b32 v5, v139, v143, s80 bitop3:0x7e
    v_or3_b32 v220, v4, v5, v220
    v_cmp_lt_u32 vcc, 0xffff, v220
    v_fma_f32 v8, -v216, v196, v8
    v_fma_f32 v9, -v216, v197, v9
    s_or_b64 vcc, vcc, s[100:101]
    s_cbranch_scc1 RETRY_D
CONT_D:
    v_mul_f32 v8, v8, v217
    v_mul_f32 v8, v8, v9
    v_fma_f32 v4, -v216, v194, v112
    v_fma_f32 v5, -v216, v195, v113
    v_mul_f32 v4, v4, v217
    v_mul_f32 v4, v4, v5
    v_cvt_pk_bf16_f32 v5, v4, v8
    ds_write_b16 v33, v5
    ds_write_b16_d16_hi v34, v5
    s_cmp_eq_u32 s76, 3
    s_cbranch_scc1 W3_E
    s_waitcnt lgkmcnt(0)
    s_barrier
    ds_read_b128 v[172:175], v79
    ds_read_b128 v[156:159], v25 offset:512
    ds_read_b128 v[160:163], v25 offset:640
    ds_read_b128 v[164:167], v25 offset:768
    ds_read_b128 v[168:171], v25 offset:896
    s_waitcnt lgkmcnt(4)
    v_mfma_f32_16x16x32_bf16 v[116:119], v[172:175], a[248:251], 0
    s_waitcnt lgkmcnt(3)
    v_smfmac_f32_16x16x64_bf16 v[116:119], v[156:159], a[216:223], v77
    s_waitcnt lgkmcnt(2)
    v_smfmac_f32_16x16x64_bf16 v[116:119], v[160:163], a[224:231], v77
    s_waitcnt lgkmcnt(1)
    v_smfmac_f32_16x16x64_bf16 v[116:119], v[164:167], a[232:239], v77
    s_waitcnt lgkmcnt(0)
    v_smfmac_f32_16x16x64_bf16 v[116:119], v[168:171], a[240:247], v77
    s_nop 7
    v_add_f32 v4, v116, v117
    v_cvt_pk_bf16_f32 v5, v76, v4
    buffer_store_dword v5, v26, s[64:67], s90 offen sc1
    s_cmp_lg_u32 s83, 0
    s_cbranch_scc1 E_LAST
    buffer_load_dwordx4 v[156:159], v14, s[64:67], s86 offen sc1
    buffer_load_dwordx4 v[160:163], v14, s[64:67], s86 offen offset:1024 sc1
    buffer_load_dwordx4 v[164:167], v14, s[64:67], s86 offen offset:2048 sc1
    buffer_load_dwordx4 v[168:171], v14, s[64:67], s86 offen offset:3072 sc1
    s_waitcnt vmcnt(4)
    s_barrier
    s_waitcnt vmcnt(0)
CHECK_CQ:
    v_mfma_f32_16x16x32_bf16 v[120:123], v[36:39], v[156:159], 0
    v_bitop3_b32 v4, v156, v158, s10 bitop3:0x7e
    v_bitop3_b32 v5, v157, v159, s14 bitop3:0x7e
    v_or_b32 v220, v4, v5
    v_mfma_f32_16x16x32_bf16 v[120:123], v[36:39], v[160:163], v[120:123]
    v_bitop3_b32 v4, v160, v162, s10 bitop3:0x7e
    v_bitop3_b32 v5, v161, v163, s14 bitop3:0x7e
    v_or3_b32 v220, v4, v5, v220
    v_mfma_f32_16x16x32_bf16 v[120:123], v[36:39], v[164:167], v[120:123]
    v_bitop3_b32 v4, v164, v166, s10 bitop3:0x7e
    v_bitop3_b32 v5, v165, v167, s14 bitop3:0x7e
    v_or3_b32 v220, v4, v5, v220
    v_mfma_f32_16x16x32_bf16 v[120:123], v[36:39], v[168:171], v[120:123]
    v_bitop3_b32 v4, v168, v170, s10 bitop3:0x7e
    v_bitop3_b32 v5, v169, v171, s14 bitop3:0x7e
    v_or3_b32 v220, v4, v5, v220
    v_cmp_ne_u16 vcc, 0, v220
    s_nop 0
    s_cmp_lg_u64 vcc, 0
    s_cbranch_scc1 RETRY_CQ
CONT_CQ:
    s_nop 0
    v_mov_b32 v192, v120
    s_add_u32 s90, s90, 0x20000
    s_and_b32 s80, s80, 0x1fff1fff
    s_add_u32 s80, s80, 0x10001
    s_and_b32 s80, s80, 0x1fff1fff
    s_or_b32 s80, s80, 0x20002000
    s_lshr_b32 s81, s80, 16
    s_lshl_b32 s82, s80, 16
    s_and_b32 s93, s80, 0xffff0000
    v_mov_b32 v4, s82
    v_mov_b32 v5, s93
    s_mov_b32 vcc_lo, 0x55555555
    s_mov_b32 vcc_hi, 0x55555555
    v_cndmask_b32 v53, v5, v4, vcc
    s_mov_b32 vcc_lo, 0x0f0f0f0f
    s_mov_b32 vcc_hi, 0x0f0f0f0f
    v_cndmask_b32 v54, v5, v4, vcc
    v_mov_b32 v67, s80
    v_mov_b32 v71, s80
    s_mov_b32 s83, 1
Q_ENTRY:
    s_barrier
    ds_read_b64 v[100:101], v12
    s_branch Q_JOIN
E_LAST:
    s_waitcnt vmcnt(0)
    s_barrier
    s_branch FINISH
W3_C:
    s_waitcnt lgkmcnt(0)
    s_barrier
    s_cmp_lg_u32 s83, 0
    s_cbranch_scc1 W3_C2
    buffer_load_dwordx4 v[156:159], v30, s[64:67], s89 offen sc1
    buffer_load_dwordx4 v[160:163], v30, s[64:67], s89 offen offset:1536 sc1
    buffer_load_dwordx4 v[164:167], v31, s[64:67], s89 offen sc1
    buffer_load_dwordx4 v[168:171], v31, s[64:67], s89 offen offset:1536 sc1
    buffer_load_dwordx4 v[172:175], v32, s[64:67], s89 offen sc1
    buffer_load_dwordx4 v[176:179], v32, s[64:67], s89 offen offset:1536 sc1
    s_lshl_b32 s93, s77, 4
    s_add_u32 s93, s93, s78
    s_mul_i32 s93, s93, 20736
    s_add_u32 s56, s20, s93
    s_addc_u32 s57, s21, 0
    s_and_b32 s57, s57, 0xffff
    s_mov_b32 s58, 0x5100
    s_mov_b32 s59, 0x20000
    v_lshlrev_b32 v4, 7, v1
    s_mov_b32 s93, 0
    buffer_load_dword v241, v4, s[56:59], s93 offen
    s_mov_b32 s93, 8192
    buffer_load_dword v241, v4, s[56:59], s93 offen
    s_mov_b32 s93, 16384
    buffer_load_dword v241, v4, s[56:59], s93 offen
    s_waitcnt vmcnt(3)
CHECK_CH:
    v_mfma_f32_16x16x32_bf16 v[120:123], v[48:51], v[156:159], 0
    v_mfma_f32_16x16x32_bf16 v[120:123], v[48:51], v[160:163], v[120:123]
    v_mfma_f32_16x16x32_bf16 v[120:123], v[48:51], v[164:167], v[120:123]
    v_mfma_f32_16x16x32_bf16 v[120:123], v[48:51], v[168:171], v[120:123]
    v_mfma_f32_16x16x32_bf16 v[124:127], v[48:51], v[172:175], 0
    v_mfma_f32_16x16x32_bf16 v[124:127], v[48:51], v[176:179], v[124:127]
    v_bitop3_b32 v4, v157, v161, s82 bitop3:0x7e
    v_bitop3_b32 v5, v159, v163, s80 bitop3:0x7e
    v_or_b32 v220, v4, v5
    v_bitop3_b32 v4, v165, v169, s82 bitop3:0x7e
    v_bitop3_b32 v5, v167, v171, s80 bitop3:0x7e
    v_or3_b32 v220, v4, v5, v220
    v_bitop3_b32 v4, v173, v177, s82 bitop3:0x7e
    v_bitop3_b32 v5, v175, v179, s80 bitop3:0x7e
    v_or3_b32 v220, v4, v5, v220
    v_cmp_lt_u32 vcc, 0xffff, v220
    s_nop 0
    s_cmp_lg_u64 vcc, 0
    s_cbranch_scc1 RETRY_CH
CONT_CH:
    v_mov_b32 v194, v120
    v_mov_b32 v195, v121
    v_add_f32_dpp v196, v124, v124 row_ror:8 row_mask:0xf bank_mask:0xf
    v_add_f32_dpp v197, v125, v125 row_ror:8 row_mask:0xf bank_mask:0xf
W3_C2:
    s_barrier
W3_C3:
GX_ISSUE_C:
    buffer_load_dwordx4 v[128:131], v27, s[64:67], s90 offen sc1
    buffer_load_dwordx4 v[132:135], v27, s[64:67], s90 offen offset:256 sc1
    buffer_load_dwordx4 v[136:139], v27, s[64:67], s90 offen offset:512 sc1
    buffer_load_dwordx4 v[140:143], v27, s[64:67], s90 offen offset:768 sc1
    s_waitcnt vmcnt(3)
    v_mfma_f32_16x16x32_bf16 v[180:183], v[44:47], v[128:131], v[188:191]
    v_bitop3_b32 v4, v128, v130, s10 bitop3:0x7e
    v_bitop3_b32 v5, v129, v131, s14 bitop3:0x7e
    v_or_b32 v220, v4, v5
    s_waitcnt vmcnt(2)
    v_mfma_f32_16x16x32_bf16 v[180:183], v[44:47], v[132:135], v[180:183]
    v_bitop3_b32 v4, v132, v134, s10 bitop3:0x7e
    v_bitop3_b32 v5, v133, v135, s14 bitop3:0x7e
    v_or3_b32 v220, v4, v5, v220
    s_waitcnt vmcnt(1)
    v_mfma_f32_16x16x32_bf16 v[180:183], v[44:47], v[136:139], v[180:183]
    v_bitop3_b32 v4, v136, v138, s10 bitop3:0x7e
    v_bitop3_b32 v5, v137, v139, s14 bitop3:0x7e
    v_or3_b32 v220, v4, v5, v220
    s_waitcnt vmcnt(0)
    v_mfma_f32_16x16x32_bf16 v[180:183], v[44:47], v[140:143], v[180:183]
    v_bitop3_b32 v4, v140, v142, s10 bitop3:0x7e
    v_bitop3_b32 v5, v141, v143, s14 bitop3:0x7e
    v_or3_b32 v220, v4, v5, v220
    v_cmp_ne_u16 vcc, 0, v220
    s_nop 0
    s_cmp_lg_u64 vcc, 0
    s_cbranch_scc1 RETRY_C
CONT_C:
    s_nop 0
    v_cvt_pk_bf16_f32 v200, v180, v181
    v_cvt_pk_bf16_f32 v201, v182, v183
    ds_write_b64 v28, v[200:201]
    v_add_f32 v8, v180, v181
    v_mul_f32 v9, v180, v180
    v_add_f32 v57, v182, v183
    v_fmac_f32 v9, v181, v181
    v_add_f32 v8, v8, v57
    v_fmac_f32 v9, v182, v182
    v_cndmask_b32 v64, 0, v8, s[98:99]
    v_fmac_f32 v9, v183, v183
    v_cndmask_b32 v65, 0, v9, s[98:99]
    s_waitcnt lgkmcnt(0)
    s_barrier
    v_add_f32_dpp v64, v64, v64 row_ror:8 row_mask:0xf bank_mask:0xf
    v_add_f32_dpp v65, v65, v65 row_ror:8 row_mask:0xf bank_mask:0xf
    s_nop 0
    v_add_f32_dpp v64, v64, v64 row_ror:4 row_mask:0xf bank_mask:0xf
    v_add_f32_dpp v65, v65, v65 row_ror:4 row_mask:0xf bank_mask:0xf
    s_nop 0
    v_add_f32_dpp v64, v64, v64 row_ror:2 row_mask:0xf bank_mask:0xf
    v_add_f32_dpp v65, v65, v65 row_ror:2 row_mask:0xf bank_mask:0xf
    s_nop 0
    v_add_f32_dpp v64, v64, v64 row_ror:1 row_mask:0xf bank_mask:0xf
    v_add_f32_dpp v65, v65, v65 row_ror:1 row_mask:0xf bank_mask:0xf
    buffer_store_dwordx4 v[64:67], v16, s[68:71], s88 offen
    buffer_store_dwordx4 v[64:67], v16, s[72:75], s88 offen sc1
    s_add_u32 s90, s90, 0x20000
    v_add_f32 v184, v180, v56
    v_add_f32 v185, v181, v56
    v_add_f32 v186, v182, v56
    v_add_f32 v187, v183, v56
    v_cvt_pk_bf16_f32 v185, v184, v185
    v_cvt_pk_bf16_f32 v187, v186, v187
    v_lshlrev_b32 v184, 16, v185
    v_lshlrev_b32 v186, 16, v187
    v_and_b32 v185, s6, v185
    v_and_b32 v187, s6, v187
    s_cmp_lg_u32 s83, 0
    s_cbranch_scc1 W3_EPOCH
    s_mov_b32 m0, 65536
    s_mov_b32 s93, 0
    buffer_load_dwordx4 v232, s[52:55], s93 offen nt lds
    s_mov_b32 m0, 66560
    s_mov_b32 s93, 0
    buffer_load_dwordx4 v233, s[52:55], s93 offen nt lds
    s_mov_b32 m0, 67584
    s_mov_b32 s93, 0
    buffer_load_dwordx4 v234, s[52:55], s93 offen nt lds
    s_mov_b32 m0, 68608
    s_mov_b32 s93, 0
    buffer_load_dwordx4 v235, s[52:55], s93 offen nt lds
    s_mov_b32 m0, 69632
    s_mov_b32 s93, 0
    buffer_load_dwordx4 v236, s[52:55], s93 offen nt lds
    s_mov_b32 m0, 70656
    s_mov_b32 s93, 73728
    buffer_load_dwordx4 v232, s[52:55], s93 offen nt lds
    s_mov_b32 m0, 71680
    s_mov_b32 s93, 73728
    buffer_load_dwordx4 v233, s[52:55], s93 offen nt lds
    s_mov_b32 m0, 72704
    s_mov_b32 s93, 73728
    buffer_load_dwordx4 v234, s[52:55], s93 offen nt lds
    s_mov_b32 m0, 73728
    s_mov_b32 s93, 73728
    buffer_load_dwordx4 v235, s[52:55], s93 offen nt lds
    s_mov_b32 m0, 74752
    s_mov_b32 s93, 73728
    buffer_load_dwordx4 v236, s[52:55], s93 offen nt lds
    s_mov_b32 m0, 75776
    s_mov_b32 s93, 147456
    buffer_load_dwordx4 v232, s[52:55], s93 offen nt lds
    s_mov_b32 m0, 76800
    s_mov_b32 s93, 147456
    buffer_load_dwordx4 v233, s[52:55], s93 offen nt lds
    s_mov_b32 m0, 77824
    s_mov_b32 s93, 147456
    buffer_load_dwordx4 v234, s[52:55], s93 offen nt lds
    s_mov_b32 m0, 78848
    s_mov_b32 s93, 147456
    buffer_load_dwordx4 v235, s[52:55], s93 offen nt lds
    s_mov_b32 m0, 79872
    s_mov_b32 s93, 147456
    buffer_load_dwordx4 v236, s[52:55], s93 offen nt lds
    s_mov_b32 m0, 80896
    s_mov_b32 s93, 221184
    buffer_load_dwordx4 v232, s[52:55], s93 offen nt lds
    s_mov_b32 m0, 81920
    s_mov_b32 s93, 221184
    buffer_load_dwordx4 v233, s[52:55], s93 offen nt lds
    s_mov_b32 m0, 82944
    s_mov_b32 s93, 221184
    buffer_load_dwordx4 v234, s[52:55], s93 offen nt lds
    s_mov_b32 m0, 83968
    s_mov_b32 s93, 221184
    buffer_load_dwordx4 v235, s[52:55], s93 offen nt lds
    s_mov_b32 m0, 84992
    s_mov_b32 s93, 221184
    buffer_load_dwordx4 v236, s[52:55], s93 offen nt lds
    s_mov_b32 m0, 86016
    s_mov_b32 s93, 294912
    buffer_load_dwordx4 v232, s[52:55], s93 offen nt lds
    s_mov_b32 m0, 87040
    s_mov_b32 s93, 294912
    buffer_load_dwordx4 v233, s[52:55], s93 offen nt lds
    s_mov_b32 m0, 88064
    s_mov_b32 s93, 294912
    buffer_load_dwordx4 v234, s[52:55], s93 offen nt lds
    s_branch GD_L1
W3_EPOCH:
    s_cmp_lg_u32 s2, 0
    s_cbranch_scc1 GD_ACK
    v_mov_b32 v4, 0
    s_mov_b64 exec, 1
    buffer_store_dword v67, v4, s[64:67], 0 offen
    s_mov_b64 exec, -1
    s_branch GD_ACK
W3_OUT:
    v_add_f32 v184, v180, v56
    v_add_f32 v185, v181, v56
    v_add_f32 v186, v182, v56
    v_add_f32 v187, v183, v56
    v_cvt_pk_bf16_f32 v198, v184, v185
    v_cvt_pk_bf16_f32 v199, v186, v187
    buffer_store_dwordx2 v[198:199], v35, s[60:63], 0 offen
FINISH:
END:
    s_endpgm
L1_WQ:
    s_waitcnt vmcnt(14)
    ds_read_b64_tr_b16 v[82:83], v227 offset:0
    ds_read_b64_tr_b16 v[84:85], v227 offset:512
    ds_read_b64_tr_b16 v[86:87], v227 offset:1024
    ds_read_b64_tr_b16 v[88:89], v227 offset:1536
    ds_read_b64_tr_b16 v[90:91], v227 offset:2048
    ds_read_b64_tr_b16 v[92:93], v227 offset:2560
    ds_read_b64_tr_b16 v[94:95], v227 offset:3072
    ds_read_b64_tr_b16 v[96:97], v227 offset:3584
    ds_read_b64_tr_b16 v[98:99], v227 offset:4096
    s_branch BACK_WQ
L1_MODE:
    v_cmp_ne_u32 vcc, s85, v146
    s_nop 0
    s_cmp_eq_u64 vcc, 0
    s_cselect_b32 s70, 0x2a0000, 0
    s_cselect_b32 s74, 0, 0x2a0000
    buffer_store_dword v238, v13, s[68:71], s86 offen
    buffer_store_dword v238, v13, s[72:75], s86 offen sc1
    s_add_u32 m0, s94, 69632
    s_add_u32 s93, s79, 16384
    s_and_b32 s93, s93, 0xf000
    buffer_load_dwordx4 v225, s[32:35], s93 offen nt lds
    s_add_u32 m0, s94, 70656
    s_add_u32 s93, s79, 20480
    s_and_b32 s93, s93, 0xf000
    buffer_load_dwordx4 v225, s[32:35], s93 offen nt lds
    s_add_u32 m0, s94, 71680
    s_add_u32 s93, s79, 24576
    s_and_b32 s93, s93, 0xf000
    buffer_load_dwordx4 v225, s[32:35], s93 offen nt lds
    s_add_u32 m0, s94, 72704
    s_add_u32 s93, s79, 28672
    s_and_b32 s93, s93, 0xf000
    buffer_load_dwordx4 v225, s[32:35], s93 offen nt lds
    s_add_u32 m0, s94, 73728
    s_add_u32 s93, s79, 32768
    s_and_b32 s93, s93, 0xf000
    buffer_load_dwordx4 v225, s[32:35], s93 offen nt lds
    s_add_u32 m0, s94, 74752
    s_add_u32 s93, s79, 36864
    s_and_b32 s93, s93, 0xf000
    buffer_load_dwordx4 v225, s[32:35], s93 offen nt lds
    s_add_u32 m0, s94, 75776
    s_add_u32 s93, s79, 40960
    s_and_b32 s93, s93, 0xf000
    buffer_load_dwordx4 v225, s[32:35], s93 offen nt lds
    s_add_u32 m0, s94, 76800
    s_add_u32 s93, s79, 45056
    s_and_b32 s93, s93, 0xf000
    buffer_load_dwordx4 v225, s[32:35], s93 offen nt lds
    s_add_u32 m0, s94, 77824
    s_add_u32 s93, s79, 49152
    s_and_b32 s93, s93, 0xf000
    buffer_load_dwordx4 v225, s[32:35], s93 offen nt lds
    s_add_u32 m0, s94, 78848
    s_add_u32 s93, s79, 53248
    s_and_b32 s93, s93, 0xf000
    buffer_load_dwordx4 v225, s[32:35], s93 offen nt lds
    s_add_u32 m0, s94, 79872
    s_add_u32 s93, s79, 57344
    s_and_b32 s93, s93, 0xf000
    buffer_load_dwordx4 v225, s[32:35], s93 offen nt lds
    s_add_u32 m0, s94, 80896
    s_add_u32 s93, s79, 61440
    s_and_b32 s93, s93, 0xf000
    buffer_load_dwordx4 v225, s[32:35], s93 offen nt lds
    s_branch BACK_MODE
L1_PV:
    s_waitcnt vmcnt(14)
    s_barrier
    s_cmp_eq_u32 s76, 3
    s_cbranch_scc1 NOGU
    v_lshrrev_b32 v4, 2, v3
    v_mul_u32_u24 v4, 576, v4
    s_mul_i32 s93, s76, 192
    v_add_u32 v4, s93, v4
    v_and_b32 v5, 3, v1
    v_lshl_add_u32 v6, v2, 2, v5
    v_lshl_add_u32 v227, v6, 3, v4
    v_lshrrev_b32 v6, 1, v6
    v_lshl_add_u32 v4, v6, 3, v4
    v_and_b32 v5, 1, v1
    v_mul_u32_u24 v5, 20736, v5
    v_add_u32 v228, v4, v5
    ds_read_b64_tr_b16 a[128:129], v227 offset:0
    ds_read_b64_tr_b16 a[146:147], v227 offset:20736
    ds_read_b64_tr_b16 a[164:165], v228 offset:128
    ds_read_b64_tr_b16 a[130:131], v227 offset:2304
    ds_read_b64_tr_b16 a[148:149], v227 offset:23040
    ds_read_b64_tr_b16 a[166:167], v228 offset:2432
    ds_read_b64_tr_b16 a[132:133], v227 offset:4608
    ds_read_b64_tr_b16 a[150:151], v227 offset:25344
    ds_read_b64_tr_b16 a[168:169], v228 offset:4736
    ds_read_b64_tr_b16 a[134:135], v227 offset:6912
    ds_read_b64_tr_b16 a[152:153], v227 offset:27648
    ds_read_b64_tr_b16 a[170:171], v228 offset:7040
    ds_read_b64_tr_b16 a[136:137], v227 offset:9216
    ds_read_b64_tr_b16 a[154:155], v227 offset:29952
    ds_read_b64_tr_b16 a[172:173], v228 offset:9344
    ds_read_b64_tr_b16 a[138:139], v227 offset:11520
    ds_read_b64_tr_b16 a[156:157], v227 offset:32256
    ds_read_b64_tr_b16 a[174:175], v228 offset:11648
    ds_read_b64_tr_b16 a[140:141], v227 offset:13824
    ds_read_b64_tr_b16 a[158:159], v227 offset:34560
    ds_read_b64_tr_b16 a[176:177], v228 offset:13952
    ds_read_b64_tr_b16 a[142:143], v227 offset:16128
    ds_read_b64_tr_b16 a[160:161], v227 offset:36864
    ds_read_b64_tr_b16 a[178:179], v228 offset:16256
    ds_read_b64_tr_b16 a[144:145], v227 offset:18432
    ds_read_b64_tr_b16 a[162:163], v227 offset:39168
    ds_read_b64_tr_b16 a[180:181], v228 offset:18560
    s_waitcnt lgkmcnt(0)
    v_mfma_f32_4x4x4_16b_bf16 v[112:115], v[108:109], a[128:129], 0 cbsz:4 abid:0
    v_mfma_f32_4x4x4_16b_bf16 v[116:119], v[108:109], a[146:147], 0 cbsz:4 abid:0
    v_mfma_f32_4x4x4_16b_bf16 v[120:123], v[108:109], a[164:165], 0 cbsz:4 abid:0
    v_mfma_f32_4x4x4_16b_bf16 v[112:115], v[108:109], a[130:131], v[112:115] cbsz:4 abid:0
    v_mfma_f32_4x4x4_16b_bf16 v[116:119], v[108:109], a[148:149], v[116:119] cbsz:4 abid:0
    v_mfma_f32_4x4x4_16b_bf16 v[120:123], v[108:109], a[166:167], v[120:123] cbsz:4 abid:0
    v_mfma_f32_4x4x4_16b_bf16 v[112:115], v[108:109], a[132:133], v[112:115] cbsz:4 abid:0
    v_mfma_f32_4x4x4_16b_bf16 v[116:119], v[108:109], a[150:151], v[116:119] cbsz:4 abid:0
    v_mfma_f32_4x4x4_16b_bf16 v[120:123], v[108:109], a[168:169], v[120:123] cbsz:4 abid:0
    v_mfma_f32_4x4x4_16b_bf16 v[112:115], v[108:109], a[134:135], v[112:115] cbsz:4 abid:0
    v_mfma_f32_4x4x4_16b_bf16 v[116:119], v[108:109], a[152:153], v[116:119] cbsz:4 abid:0
    v_mfma_f32_4x4x4_16b_bf16 v[120:123], v[108:109], a[170:171], v[120:123] cbsz:4 abid:0
    v_mfma_f32_4x4x4_16b_bf16 v[112:115], v[108:109], a[136:137], v[112:115] cbsz:4 abid:0
    v_mfma_f32_4x4x4_16b_bf16 v[116:119], v[108:109], a[154:155], v[116:119] cbsz:4 abid:0
    v_mfma_f32_4x4x4_16b_bf16 v[120:123], v[108:109], a[172:173], v[120:123] cbsz:4 abid:0
    v_mfma_f32_4x4x4_16b_bf16 v[112:115], v[108:109], a[138:139], v[112:115] cbsz:4 abid:0
    v_mfma_f32_4x4x4_16b_bf16 v[116:119], v[108:109], a[156:157], v[116:119] cbsz:4 abid:0
    v_mfma_f32_4x4x4_16b_bf16 v[120:123], v[108:109], a[174:175], v[120:123] cbsz:4 abid:0
    v_mfma_f32_4x4x4_16b_bf16 v[112:115], v[108:109], a[140:141], v[112:115] cbsz:4 abid:0
    v_mfma_f32_4x4x4_16b_bf16 v[116:119], v[108:109], a[158:159], v[116:119] cbsz:4 abid:0
    v_mfma_f32_4x4x4_16b_bf16 v[120:123], v[108:109], a[176:177], v[120:123] cbsz:4 abid:0
    v_mfma_f32_4x4x4_16b_bf16 v[112:115], v[108:109], a[142:143], v[112:115] cbsz:4 abid:0
    v_mfma_f32_4x4x4_16b_bf16 v[116:119], v[108:109], a[160:161], v[116:119] cbsz:4 abid:0
    v_mfma_f32_4x4x4_16b_bf16 v[120:123], v[108:109], a[178:179], v[120:123] cbsz:4 abid:0
    v_mfma_f32_4x4x4_16b_bf16 v[112:115], v[108:109], a[144:145], v[112:115] cbsz:4 abid:0
    v_mfma_f32_4x4x4_16b_bf16 v[116:119], v[108:109], a[162:163], v[116:119] cbsz:4 abid:0
    v_mfma_f32_4x4x4_16b_bf16 v[120:123], v[108:109], a[180:181], v[120:123] cbsz:4 abid:0
    s_nop 3
    v_cvt_pk_bf16_f32 v200, v112, v116
    v_cvt_pk_bf16_f32 v201, v120, v54
NOGU:
    buffer_store_dwordx2 v[200:201], v29, s[68:71], s89 offen
    buffer_store_dwordx2 v[200:201], v29, s[72:75], s89 offen sc1
    v_lshrrev_b32 v4, 2, v3
    v_lshlrev_b32 v5, 2, v4
    v_bfe_u32 v6, v1, 1, 1
    v_lshl_add_u32 v6, v2, 1, v6
    v_xor_b32 v6, v6, v5
    v_lshlrev_b32 v4, 8, v4
    v_lshl_add_u32 v4, v6, 4, v4
    v_and_b32 v5, 1, v1
    v_lshl_add_u32 v4, v5, 3, v4
    s_add_u32 s93, s94, 65536
    v_add_u32 v227, s93, v4
    v_xor_b32 v228, 128, v227
    s_mul_i32 s95, s76, 5120
    s_mul_i32 s96, s76, 73728
    s_add_u32 m0, s95, 138240
    s_nop 0
    buffer_load_dwordx4 v232, s[40:43], s96 offen nt lds
    s_add_u32 m0, s95, 139264
    s_nop 0
    buffer_load_dwordx4 v233, s[40:43], s96 offen nt lds
    s_add_u32 m0, s95, 140288
    s_nop 0
    buffer_load_dwordx4 v234, s[40:43], s96 offen nt lds
    s_add_u32 m0, s95, 141312
    s_nop 0
    buffer_load_dwordx4 v235, s[40:43], s96 offen nt lds
    s_add_u32 m0, s95, 142336
    s_nop 0
    buffer_load_dwordx4 v236, s[40:43], s96 offen nt lds
    s_waitcnt vmcnt(63)
    ds_read_b64_tr_b16 a[64:65], v227 offset:0
    ds_read_b64_tr_b16 a[66:67], v228 offset:0
    ds_read_b64_tr_b16 a[68:69], v227 offset:1024
    ds_read_b64_tr_b16 a[70:71], v228 offset:1024
    ds_read_b64_tr_b16 a[72:73], v227 offset:2048
    ds_read_b64_tr_b16 a[74:75], v228 offset:2048
    ds_read_b64_tr_b16 a[76:77], v227 offset:3072
    ds_read_b64_tr_b16 a[78:79], v228 offset:3072
    s_waitcnt vmcnt(15)
    ds_read_b64_tr_b16 a[80:81], v227 offset:4096
    ds_read_b64_tr_b16 a[82:83], v228 offset:4096
    ds_read_b64_tr_b16 a[84:85], v227 offset:5120
    ds_read_b64_tr_b16 a[86:87], v228 offset:5120
    ds_read_b64_tr_b16 a[88:89], v227 offset:6144
    ds_read_b64_tr_b16 a[90:91], v228 offset:6144
    ds_read_b64_tr_b16 a[92:93], v227 offset:7168
    ds_read_b64_tr_b16 a[94:95], v228 offset:7168
    s_waitcnt vmcnt(11)
    ds_read_b64_tr_b16 a[96:97], v227 offset:8192
    ds_read_b64_tr_b16 a[98:99], v228 offset:8192
    ds_read_b64_tr_b16 a[100:101], v227 offset:9216
    ds_read_b64_tr_b16 a[102:103], v228 offset:9216
    ds_read_b64_tr_b16 a[104:105], v227 offset:10240
    ds_read_b64_tr_b16 a[106:107], v228 offset:10240
    ds_read_b64_tr_b16 a[108:109], v227 offset:11264
    ds_read_b64_tr_b16 a[110:111], v228 offset:11264
    s_waitcnt lgkmcnt(0)
    s_branch BACK_PV
L1_PV2:
    s_waitcnt vmcnt(7)
    ds_read_b64_tr_b16 a[112:113], v227 offset:12288
    ds_read_b64_tr_b16 a[114:115], v228 offset:12288
    ds_read_b64_tr_b16 a[116:117], v227 offset:13312
    ds_read_b64_tr_b16 a[118:119], v228 offset:13312
    ds_read_b64_tr_b16 a[120:121], v227 offset:14336
    ds_read_b64_tr_b16 a[122:123], v228 offset:14336
    ds_read_b64_tr_b16 a[124:125], v227 offset:15360
    ds_read_b64_tr_b16 a[126:127], v228 offset:15360
    s_waitcnt lgkmcnt(0)
    s_branch BACK_PV2
RETRY_CR:
    s_sub_u32 s84, s84, 1
    s_cbranch_scc1 GIVEUP_CR
    buffer_load_dwordx4 v[156:159], v14, s[64:67], s86 offen sc1
    buffer_load_dwordx4 v[160:163], v14, s[64:67], s86 offen offset:1024 sc1
    buffer_load_dwordx4 v[164:167], v14, s[64:67], s86 offen offset:2048 sc1
    buffer_load_dwordx4 v[168:171], v14, s[64:67], s86 offen offset:3072 sc1
    s_waitcnt vmcnt(0)
    s_branch CHECK_CR
GIVEUP_CR:
    s_mov_b32 s84, 0
    s_branch CONT_CR
RETRY_E:
    s_sub_u32 s84, s84, 1
    s_cbranch_scc0 GX_ISSUE_E
    s_mov_b32 s84, 0
    s_branch CONT_E
RETRY_A:
    s_sub_u32 s84, s84, 1
    s_cbranch_scc0 GA_ISSUE
    s_mov_b32 s84, 0
    s_branch CONT_A
RETRY_B:
    s_sub_u32 s84, s84, 1
    s_cbranch_scc0 GB_ISSUE
    s_mov_b32 s84, 0
    s_branch CONT_B
RETRY_CG:
    s_sub_u32 s84, s84, 1
    s_cbranch_scc1 GIVEUP_CG
    buffer_load_dwordx4 v[156:159], v30, s[64:67], s89 offen sc1
    buffer_load_dwordx4 v[160:163], v30, s[64:67], s89 offen offset:1536 sc1
    buffer_load_dwordx4 v[164:167], v31, s[64:67], s89 offen sc1
    buffer_load_dwordx4 v[168:171], v31, s[64:67], s89 offen offset:1536 sc1
    buffer_load_dwordx4 v[172:175], v32, s[64:67], s89 offen sc1
    buffer_load_dwordx4 v[176:179], v32, s[64:67], s89 offen offset:1536 sc1
    s_waitcnt vmcnt(0)
    s_branch CHECK_CG
GIVEUP_CG:
    s_mov_b32 s84, 0
    s_branch CONT_CG
RETRY_D:
    s_sub_u32 s84, s84, 1
    s_cbranch_scc0 GD_ISSUE
    s_mov_b32 s84, 0
    s_branch CONT_D
RETRY_CQ:
    s_sub_u32 s84, s84, 1
    s_cbranch_scc1 GIVEUP_CQ
    buffer_load_dwordx4 v[156:159], v14, s[64:67], s86 offen sc1
    buffer_load_dwordx4 v[160:163], v14, s[64:67], s86 offen offset:1024 sc1
    buffer_load_dwordx4 v[164:167], v14, s[64:67], s86 offen offset:2048 sc1
    buffer_load_dwordx4 v[168:171], v14, s[64:67], s86 offen offset:3072 sc1
    s_waitcnt vmcnt(0)
    s_branch CHECK_CQ
GIVEUP_CQ:
    s_mov_b32 s84, 0
    s_branch CONT_CQ
RETRY_CH:
    s_sub_u32 s84, s84, 1
    s_cbranch_scc1 GIVEUP_CH
    buffer_load_dwordx4 v[156:159], v30, s[64:67], s89 offen sc1
    buffer_load_dwordx4 v[160:163], v30, s[64:67], s89 offen offset:1536 sc1
    buffer_load_dwordx4 v[164:167], v31, s[64:67], s89 offen sc1
    buffer_load_dwordx4 v[168:171], v31, s[64:67], s89 offen offset:1536 sc1
    buffer_load_dwordx4 v[172:175], v32, s[64:67], s89 offen sc1
    buffer_load_dwordx4 v[176:179], v32, s[64:67], s89 offen offset:1536 sc1
    s_waitcnt vmcnt(0)
    s_branch CHECK_CH
GIVEUP_CH:
    s_mov_b32 s84, 0
    s_branch CONT_CH
RETRY_C:
    s_sub_u32 s84, s84, 1
    s_cbranch_scc0 GX_ISSUE_C
    s_mov_b32 s84, 0
    s_branch CONT_C
CODE_END:
.section .rodata,"a"
.p2align 6
.amdhsa_kernel interleave_layers__sliding_block_cached__glu_gated_bilinear__decode_kernel
  .amdhsa_next_free_vgpr 512
  .amdhsa_next_free_sgpr 102
  .amdhsa_accum_offset 256
  .amdhsa_group_segment_fixed_size 0
  .amdhsa_kernarg_size 96
  .amdhsa_user_sgpr_count 2
  .amdhsa_user_sgpr_kernarg_segment_ptr 1
  .amdhsa_system_sgpr_workgroup_id_x 1
.end_amdhsa_kernel
```
